```python
import torch

def _softmax(x, axis=-1):
    return torch.softmax(x, dim=axis)
def _gelu(x):
    return torch.nn.functional.gelu(x, approximate="tanh")
def _silu(x):
    return torch.nn.functional.silu(x)
def _sigmoid(x):
    return torch.sigmoid(x)
def _layernorm(x, axis=-1, eps=1e-5):
    m = x.mean(dim=axis, keepdim=True)
    v = x.var(dim=axis, keepdim=True, unbiased=False)
    return (x - m) / torch.sqrt(v + eps)
def _scatter_add(tgt, idx, src, axis=0):
    return tgt.clone().index_add_(axis, idx, src)
def _segment_sum(src, seg, n):
    out = torch.zeros((n,) + src.shape[1:], dtype=src.dtype)
    return out.index_add_(0, seg, src)
def _pad(x, pw):
    flat = tuple(v for pair in reversed(pw) for v in pair)
    return torch.nn.functional.pad(x, flat)

kernel_name = 'sequential_preLN__mha_block__glu_gated_reglu__prompt'

def setup_inputs():

    _w = (lambda a: (lambda t: t.to(torch.bfloat16) if t.is_floating_point() else t)(torch.as_tensor(a)))
    def _A_setup():
        B, S, D, H = 1, 2048, 448, 16
        return {
            "x": _w((lambda *s: torch.randn(*s, dtype=torch.bfloat16) * 0.05)(B, S, D)),
            "wqkv": _w((lambda *s: torch.randn(*s, dtype=torch.bfloat16) * 0.05)(D, 3 * D)),
            "wo": _w((lambda *s: torch.randn(*s, dtype=torch.bfloat16) * 0.05)(D, D)),
        }
    _A_in = _A_setup()

    def _B_setup():
        B, S, D, F = 1, 2048, 448, 1792
        return {
            "x": _w((lambda *s: torch.randn(*s, dtype=torch.bfloat16) * 0.05)(B, S, D)),
            "W_gate": _w((lambda *s: torch.randn(*s, dtype=torch.bfloat16) * 0.4)(D, F) * (2.0 / D) ** 0.5),
            "W_up": _w((lambda *s: torch.randn(*s, dtype=torch.bfloat16) * 0.4)(D, F) * (2.0 / D) ** 0.5),
            "W_down": _w((lambda *s: torch.randn(*s, dtype=torch.bfloat16) * 0.4)(F, D) * (1.0 / F) ** 0.5),
        }
    _B_in = _B_setup()

    return {
        "A_x": _A_in["x"],
        "A_wqkv": _A_in["wqkv"],
        "A_wo": _A_in["wo"],
        "B_x": _B_in["x"],
        "B_W_gate": _B_in["W_gate"],
        "B_W_up": _B_in["W_up"],
        "B_W_down": _B_in["W_down"],
    }

def reference(A_x, A_wqkv, A_wo, B_x, B_W_gate, B_W_up, B_W_down):
    def _A_ref(x, wqkv, wo):
        B, S, D = x.shape
        H = 16
        Dh = D // H
        qkv = (lambda x, *d: x.permute(*d))((x @ wqkv).reshape(B, S, 3, H, Dh), 2, 0, 3, 1, 4)
        q, k, v = qkv[0], qkv[1], qkv[2]
        scores = torch.einsum("bhqd,bhkd->bhqk", q, k) * (Dh ** -0.5)
        p = _softmax(scores, axis=-1)
        o = torch.einsum("bhqk,bhkd->bhqd", p, v)
        return (lambda x, *d: x.permute(*d))(o, 0, 2, 1, 3).reshape(B, S, D) @ wo

    def _B_ref(x, W_gate, W_up, W_down):
        gate = torch.einsum("bsd,df->bsf", x, W_gate)
        up = torch.einsum("bsd,df->bsf", x, W_up)
        gate = gate * (lambda x, dt: x.to(dt))(gate > 0, gate.dtype)
        h = gate * up
        return torch.einsum("bsf,fd->bsd", h, W_down)

    x = A_x
    h = x + _A_ref(_layernorm(x, axis=-1), A_wqkv, A_wo)
    h2 = h + _B_ref(_layernorm(h, axis=-1), B_W_gate, B_W_up, B_W_down)
    return h2
```

```asm
; @launch grid=(256,1,1) block=(512,1,1) lds=163840
.amdgcn_target "amdgcn-amd-amdhsa--gfx950"
.text
.globl sequential_preLN__mha_block__glu_gated_reglu__prompt_kernel
.p2align 8
.type sequential_preLN__mha_block__glu_gated_reglu__prompt_kernel,@function
sequential_preLN__mha_block__glu_gated_reglu__prompt_kernel:
    s_cmp_ge_u32 s2, 256
    s_cbranch_scc1 L_end
    s_load_dwordx16 s[4:19], s[0:1], 0
    s_load_dwordx4 s[20:23], s[0:1], 64
    v_lshrrev_b32 v1, 6, v0
    v_and_b32 v0, 63, v0
    v_readfirstlane_b32 s3, v1
    s_and_b32 s36, s2, 7
    s_lshr_b32 s37, s2, 3
    s_cmp_lg_u32 s3, 7
    s_cbranch_scc1 L_t1_1
    s_cmp_ge_u32 s37, 9
    s_cbranch_scc1 L_t1_1
    s_getpc_b64 s[46:47]
L_pc_2:
    v_and_b32 v5, 31, v0
    v_lshl_add_u32 v5, s37, 5, v5
    v_lshlrev_b32 v5, 7, v5
    v_min_u32 v5, L_end-L_pc_2, v5
    v_mov_b32 v7, s47
    v_add_co_u32 v6, vcc, s46, v5
    s_nop 1
    v_addc_co_u32 v7, vcc, 0, v7, vcc
    global_load_dword v9, v[6:7], off
L_t1_1:
    v_lshrrev_b32 v1, 5, v0
    v_and_b32 v2, 31, v0
    v_lshlrev_b32 v3, 4, v0
    s_and_b32 s38, s3, 3
    s_lshr_b32 s39, s3, 2
    s_waitcnt lgkmcnt(0)
    s_mov_b32 s24, s22
    s_mov_b32 s25, s23
    s_mov_b32 s26, 20514944
    s_mov_b32 s27, 0x20000
    s_cmp_ge_u32 s2, 224
    s_cbranch_scc1 L_T
    s_lshl_b32 s40, s36, 2
    s_and_b32 s41, s37, 3
    s_add_u32 s40, s40, s41
    s_lshr_b32 s41, s37, 2
    s_mov_b32 s28, s4
    s_mov_b32 s29, s5
    s_mov_b32 s30, 1835008
    s_mov_b32 s31, 0x20000
    s_mov_b32 s32, s6
    s_mov_b32 s33, s7
    s_mov_b32 s34, 1204224
    s_mov_b32 s35, 0x20000
    v_lshrrev_b32 v4, 3, v0
    v_and_b32 v5, 7, v0
    v_mul_u32_u24 v6, 896, v4
    v_lshl_add_u32 v6, v5, 4, v6
    s_add_u32 s46, s3, s41
    s_and_b32 s46, s46, 7
    s_mul_i32 s42, s40, 57344
    s_mul_i32 s43, s46, 7168
    s_add_u32 s42, s42, s43
    s_cmp_lg_u32 s3, 4
    s_cbranch_scc1 L_t0_3
    v_and_b32 v7, 15, v0
    v_min_u32 v7, 13, v7
    s_mul_i32 s45, s40, 14
    v_add_u32 v7, s45, v7
    v_mul_u32_u24 v7, 2688, v7
    v_lshrrev_b32 v8, 4, v0
    v_min_u32 v8, 2, v8
    v_mul_u32_u24 v8, 896, v8
    v_add_u32 v7, v7, v8
    s_lshl_b32 s45, s41, 7
    buffer_load_dword v9, v7, s[32:35], s45 offen
L_t0_3:
    buffer_load_dwordx4 v[128:131], v6, s[28:31], s42 offen offset:0
    buffer_load_dwordx4 v[132:135], v6, s[28:31], s42 offen offset:128
    buffer_load_dwordx4 v[136:139], v6, s[28:31], s42 offen offset:256
    buffer_load_dwordx4 v[140:143], v6, s[28:31], s42 offen offset:384
    buffer_load_dwordx4 v[144:147], v6, s[28:31], s42 offen offset:512
    buffer_load_dwordx4 v[148:151], v6, s[28:31], s42 offen offset:640
    buffer_load_dwordx4 v[152:155], v6, s[28:31], s42 offen offset:768
    s_and_b32 s47, s46, 3
    s_lshl_b32 s47, s47, 3
    v_add_u32 v4, s47, v4
    s_lshr_b32 s47, s46, 2
    s_mul_i32 s47, s47, 28672
    v_xor_b32 v4, v4, v5
    v_lshlrev_b32 v4, 4, v4
    v_lshl_add_u32 v4, v5, 9, v4
    v_add_u32 v4, s47, v4
    s_and_b32 s44, s3, 1
    s_bfe_u32 s45, s3, 0x10001
    s_mul_i32 s48, s44, 28672
    v_add_u32 v5, 0, v1
    v_xor_b32 v5, v5, v2
    v_lshlrev_b32 v5, 4, v5
    v_lshl_add_u32 v5, v1, 9, v5
    v_add_u32 v10, s48, v5
    v_add_u32 v5, 2, v1
    v_xor_b32 v5, v5, v2
    v_lshlrev_b32 v5, 4, v5
    v_lshl_add_u32 v5, v1, 9, v5
    v_add_u32 v11, s48, v5
    v_add_u32 v5, 4, v1
    v_xor_b32 v5, v5, v2
    v_lshlrev_b32 v5, 4, v5
    v_lshl_add_u32 v5, v1, 9, v5
    v_add_u32 v12, s48, v5
    v_add_u32 v5, 6, v1
    v_xor_b32 v5, v5, v2
    v_lshlrev_b32 v5, 4, v5
    v_lshl_add_u32 v5, v1, 9, v5
    v_add_u32 v13, s48, v5
    v_bfe_u32 v5, v0, 2, 2
    v_lshl_add_u32 v6, v1, 3, v5
    v_lshlrev_b32 v6, 7, v6
    v_bfe_u32 v7, v0, 4, 1
    v_lshlrev_b32 v7, 5, v7
    v_and_b32 v8, 3, v0
    v_lshl_add_u32 v7, v8, 3, v7
    s_lshl_b32 s48, s45, 6
    v_add_u32 v7, s48, v7
    v_lshrrev_b32 v5, 1, v5
    v_lshlrev_b32 v5, 6, v5
    v_xor_b32 v7, v7, v5
    v_add_u32 v112, v6, v7
    v_add_u32 v112, 57344, v112
    v_add_u32 v113, 49152, v112
    v_and_b32 v7, 0xffffffe7, v112
    v_and_b32 v8, 1, v0
    v_lshl_add_u32 v7, v8, 4, v7
    v_bfe_u32 v8, v0, 1, 1
    v_lshl_add_u32 v14, v8, 3, v7
    v_add_u32 v15, 49152, v14
    v_lshrrev_b32 v6, 3, v0
    v_bfe_u32 v7, v0, 4, 1
    v_lshlrev_b32 v7, 2, v7
    v_and_b32 v8, 7, v0
    v_xor_b32 v7, v7, v8
    v_mul_u32_u24 v6, 2688, v6
    v_lshl_add_u32 v114, v7, 4, v6
    s_mul_i32 s42, s3, 21504
    s_lshl_b32 s43, s41, 7
    s_add_u32 s42, s42, s43
    s_lshl_b32 s43, s3, 10
    s_add_u32 s43, s43, 57344
    s_mov_b32 s46, 991054117
    s_mov_b32 s47, 925353388
    s_waitcnt vmcnt(6)
    v_lshlrev_b32 v16, 16, v128
    v_and_b32 v17, 0xffff0000, v128
    v_pk_mul_f32 v[8:9], v[16:17], v[16:17]
    v_lshlrev_b32 v18, 16, v129
    v_and_b32 v19, 0xffff0000, v129
    v_pk_mul_f32 v[118:119], v[18:19], v[18:19]
    v_lshlrev_b32 v20, 16, v130
    v_and_b32 v21, 0xffff0000, v130
    v_pk_add_f32 v[6:7], v[16:17], v[20:21]
    v_pk_fma_f32 v[8:9], v[20:21], v[20:21], v[8:9]
    v_lshlrev_b32 v22, 16, v131
    v_and_b32 v23, 0xffff0000, v131
    v_pk_add_f32 v[116:117], v[18:19], v[22:23]
    v_pk_fma_f32 v[118:119], v[22:23], v[22:23], v[118:119]
    s_waitcnt vmcnt(5)
    v_lshlrev_b32 v24, 16, v132
    v_and_b32 v25, 0xffff0000, v132
    v_pk_add_f32 v[6:7], v[6:7], v[24:25]
    v_pk_fma_f32 v[8:9], v[24:25], v[24:25], v[8:9]
    v_lshlrev_b32 v26, 16, v133
    v_and_b32 v27, 0xffff0000, v133
    v_pk_add_f32 v[116:117], v[116:117], v[26:27]
    v_pk_fma_f32 v[118:119], v[26:27], v[26:27], v[118:119]
    v_lshlrev_b32 v28, 16, v134
    v_and_b32 v29, 0xffff0000, v134
    v_pk_add_f32 v[6:7], v[6:7], v[28:29]
    v_pk_fma_f32 v[8:9], v[28:29], v[28:29], v[8:9]
    v_lshlrev_b32 v30, 16, v135
    v_and_b32 v31, 0xffff0000, v135
    v_pk_add_f32 v[116:117], v[116:117], v[30:31]
    v_pk_fma_f32 v[118:119], v[30:31], v[30:31], v[118:119]
    s_waitcnt vmcnt(4)
    v_lshlrev_b32 v32, 16, v136
    v_and_b32 v33, 0xffff0000, v136
    v_pk_add_f32 v[6:7], v[6:7], v[32:33]
    v_pk_fma_f32 v[8:9], v[32:33], v[32:33], v[8:9]
    v_lshlrev_b32 v34, 16, v137
    v_and_b32 v35, 0xffff0000, v137
    v_pk_add_f32 v[116:117], v[116:117], v[34:35]
    v_pk_fma_f32 v[118:119], v[34:35], v[34:35], v[118:119]
    v_lshlrev_b32 v36, 16, v138
    v_and_b32 v37, 0xffff0000, v138
    v_pk_add_f32 v[6:7], v[6:7], v[36:37]
    v_pk_fma_f32 v[8:9], v[36:37], v[36:37], v[8:9]
    v_lshlrev_b32 v38, 16, v139
    v_and_b32 v39, 0xffff0000, v139
    v_pk_add_f32 v[116:117], v[116:117], v[38:39]
    v_pk_fma_f32 v[118:119], v[38:39], v[38:39], v[118:119]
    s_waitcnt vmcnt(3)
    v_lshlrev_b32 v40, 16, v140
    v_and_b32 v41, 0xffff0000, v140
    v_pk_add_f32 v[6:7], v[6:7], v[40:41]
    v_pk_fma_f32 v[8:9], v[40:41], v[40:41], v[8:9]
    v_lshlrev_b32 v42, 16, v141
    v_and_b32 v43, 0xffff0000, v141
    v_pk_add_f32 v[116:117], v[116:117], v[42:43]
    v_pk_fma_f32 v[118:119], v[42:43], v[42:43], v[118:119]
    v_lshlrev_b32 v44, 16, v142
    v_and_b32 v45, 0xffff0000, v142
    v_pk_add_f32 v[6:7], v[6:7], v[44:45]
    v_pk_fma_f32 v[8:9], v[44:45], v[44:45], v[8:9]
    v_lshlrev_b32 v46, 16, v143
    v_and_b32 v47, 0xffff0000, v143
    v_pk_add_f32 v[116:117], v[116:117], v[46:47]
    v_pk_fma_f32 v[118:119], v[46:47], v[46:47], v[118:119]
    s_waitcnt vmcnt(2)
    s_add_u32 m0, s43, 0
    s_add_u32 s49, s42, 0
    buffer_load_dwordx4 v114, s[32:35], s49 offen lds
    v_lshlrev_b32 v48, 16, v144
    v_and_b32 v49, 0xffff0000, v144
    v_pk_add_f32 v[6:7], v[6:7], v[48:49]
    v_pk_fma_f32 v[8:9], v[48:49], v[48:49], v[8:9]
    v_lshlrev_b32 v50, 16, v145
    v_and_b32 v51, 0xffff0000, v145
    v_pk_add_f32 v[116:117], v[116:117], v[50:51]
    v_pk_fma_f32 v[118:119], v[50:51], v[50:51], v[118:119]
    v_lshlrev_b32 v52, 16, v146
    v_and_b32 v53, 0xffff0000, v146
    v_pk_add_f32 v[6:7], v[6:7], v[52:53]
    v_pk_fma_f32 v[8:9], v[52:53], v[52:53], v[8:9]
    v_lshlrev_b32 v54, 16, v147
    v_and_b32 v55, 0xffff0000, v147
    v_pk_add_f32 v[116:117], v[116:117], v[54:55]
    v_pk_fma_f32 v[118:119], v[54:55], v[54:55], v[118:119]
    s_waitcnt vmcnt(2)
    s_add_u32 m0, s43, 8192
    s_add_u32 s49, s42, 896
    buffer_load_dwordx4 v114, s[32:35], s49 offen lds
    v_lshlrev_b32 v56, 16, v148
    v_and_b32 v57, 0xffff0000, v148
    v_pk_add_f32 v[6:7], v[6:7], v[56:57]
    v_pk_fma_f32 v[8:9], v[56:57], v[56:57], v[8:9]
    v_lshlrev_b32 v58, 16, v149
    v_and_b32 v59, 0xffff0000, v149
    v_pk_add_f32 v[116:117], v[116:117], v[58:59]
    v_pk_fma_f32 v[118:119], v[58:59], v[58:59], v[118:119]
    v_lshlrev_b32 v60, 16, v150
    v_and_b32 v61, 0xffff0000, v150
    v_pk_add_f32 v[6:7], v[6:7], v[60:61]
    v_pk_fma_f32 v[8:9], v[60:61], v[60:61], v[8:9]
    v_lshlrev_b32 v62, 16, v151
    v_and_b32 v63, 0xffff0000, v151
    v_pk_add_f32 v[116:117], v[116:117], v[62:63]
    v_pk_fma_f32 v[118:119], v[62:63], v[62:63], v[118:119]
    s_waitcnt vmcnt(2)
    s_add_u32 m0, s43, 16384
    s_add_u32 s49, s42, 1792
    buffer_load_dwordx4 v114, s[32:35], s49 offen lds
    v_lshlrev_b32 v64, 16, v152
    v_and_b32 v65, 0xffff0000, v152
    v_pk_add_f32 v[6:7], v[6:7], v[64:65]
    v_pk_fma_f32 v[8:9], v[64:65], v[64:65], v[8:9]
    v_lshlrev_b32 v66, 16, v153
    v_and_b32 v67, 0xffff0000, v153
    v_pk_add_f32 v[116:117], v[116:117], v[66:67]
    v_pk_fma_f32 v[118:119], v[66:67], v[66:67], v[118:119]
    v_lshlrev_b32 v68, 16, v154
    v_and_b32 v69, 0xffff0000, v154
    v_pk_add_f32 v[6:7], v[6:7], v[68:69]
    v_pk_fma_f32 v[8:9], v[68:69], v[68:69], v[8:9]
    v_lshlrev_b32 v70, 16, v155
    v_and_b32 v71, 0xffff0000, v155
    v_pk_add_f32 v[116:117], v[116:117], v[70:71]
    v_pk_fma_f32 v[118:119], v[70:71], v[70:71], v[118:119]
    v_pk_add_f32 v[6:7], v[6:7], v[116:117]
    v_pk_add_f32 v[8:9], v[8:9], v[118:119]
    s_add_u32 m0, s43, 24576
    s_add_u32 s49, s42, 172032
    buffer_load_dwordx4 v114, s[32:35], s49 offen lds
    v_add_f32 v6, v6, v7
    v_add_f32 v8, v8, v9
    s_nop 0
    v_add_f32_dpp v6, v6, v6 quad_perm:[1,0,3,2] row_mask:0xf bank_mask:0xf
    v_add_f32_dpp v8, v8, v8 quad_perm:[1,0,3,2] row_mask:0xf bank_mask:0xf
    s_nop 0
    v_add_f32_dpp v6, v6, v6 quad_perm:[2,3,0,1] row_mask:0xf bank_mask:0xf
    v_add_f32_dpp v8, v8, v8 quad_perm:[2,3,0,1] row_mask:0xf bank_mask:0xf
    s_nop 0
    v_add_f32_dpp v6, v6, v6 row_half_mirror row_mask:0xf bank_mask:0xf
    v_add_f32_dpp v8, v8, v8 row_half_mirror row_mask:0xf bank_mask:0xf
    s_nop 0
    v_mul_f32 v6, s46, v6
    v_mul_f32 v8, s46, v8
    v_fma_f32 v8, -v6, v6, v8
    v_max_f32 v8, 0, v8
    v_add_f32 v8, s47, v8
    v_rsq_f32 v8, v8
    s_nop 0
    v_mul_f32 v6, v6, v8
    v_sub_f32 v6, 0, v6
    v_pk_fma_f32 v[16:17], v[16:17], v[8:9], v[6:7] op_sel_hi:[1,0,0]
    v_pk_fma_f32 v[18:19], v[18:19], v[8:9], v[6:7] op_sel_hi:[1,0,0]
    v_pk_fma_f32 v[20:21], v[20:21], v[8:9], v[6:7] op_sel_hi:[1,0,0]
    v_pk_fma_f32 v[22:23], v[22:23], v[8:9], v[6:7] op_sel_hi:[1,0,0]
    v_cvt_pk_bf16_f32 v72, v16, v17
    v_cvt_pk_bf16_f32 v73, v18, v19
    v_cvt_pk_bf16_f32 v74, v20, v21
    v_cvt_pk_bf16_f32 v75, v22, v23
    ds_write_b128 v4, v[72:75] offset:0
    s_add_u32 m0, s43, 32768
    s_add_u32 s49, s42, 172928
    buffer_load_dwordx4 v114, s[32:35], s49 offen lds
    v_pk_fma_f32 v[24:25], v[24:25], v[8:9], v[6:7] op_sel_hi:[1,0,0]
    v_pk_fma_f32 v[26:27], v[26:27], v[8:9], v[6:7] op_sel_hi:[1,0,0]
    v_pk_fma_f32 v[28:29], v[28:29], v[8:9], v[6:7] op_sel_hi:[1,0,0]
    v_pk_fma_f32 v[30:31], v[30:31], v[8:9], v[6:7] op_sel_hi:[1,0,0]
    v_cvt_pk_bf16_f32 v76, v24, v25
    v_cvt_pk_bf16_f32 v77, v26, v27
    v_cvt_pk_bf16_f32 v78, v28, v29
    v_cvt_pk_bf16_f32 v79, v30, v31
    ds_write_b128 v4, v[76:79] offset:4096
    s_add_u32 m0, s43, 40960
    s_add_u32 s49, s42, 173824
    buffer_load_dwordx4 v114, s[32:35], s49 offen lds
    v_pk_fma_f32 v[32:33], v[32:33], v[8:9], v[6:7] op_sel_hi:[1,0,0]
    v_pk_fma_f32 v[34:35], v[34:35], v[8:9], v[6:7] op_sel_hi:[1,0,0]
    v_pk_fma_f32 v[36:37], v[36:37], v[8:9], v[6:7] op_sel_hi:[1,0,0]
    v_pk_fma_f32 v[38:39], v[38:39], v[8:9], v[6:7] op_sel_hi:[1,0,0]
    v_cvt_pk_bf16_f32 v80, v32, v33
    v_cvt_pk_bf16_f32 v81, v34, v35
    v_cvt_pk_bf16_f32 v82, v36, v37
    v_cvt_pk_bf16_f32 v83, v38, v39
    ds_write_b128 v4, v[80:83] offset:8192
    v_pk_fma_f32 v[40:41], v[40:41], v[8:9], v[6:7] op_sel_hi:[1,0,0]
    v_pk_fma_f32 v[42:43], v[42:43], v[8:9], v[6:7] op_sel_hi:[1,0,0]
    v_pk_fma_f32 v[44:45], v[44:45], v[8:9], v[6:7] op_sel_hi:[1,0,0]
    v_pk_fma_f32 v[46:47], v[46:47], v[8:9], v[6:7] op_sel_hi:[1,0,0]
    v_cvt_pk_bf16_f32 v84, v40, v41
    v_cvt_pk_bf16_f32 v85, v42, v43
    v_cvt_pk_bf16_f32 v86, v44, v45
    v_cvt_pk_bf16_f32 v87, v46, v47
    ds_write_b128 v4, v[84:87] offset:12288
    v_pk_fma_f32 v[48:49], v[48:49], v[8:9], v[6:7] op_sel_hi:[1,0,0]
    v_pk_fma_f32 v[50:51], v[50:51], v[8:9], v[6:7] op_sel_hi:[1,0,0]
    v_pk_fma_f32 v[52:53], v[52:53], v[8:9], v[6:7] op_sel_hi:[1,0,0]
    v_pk_fma_f32 v[54:55], v[54:55], v[8:9], v[6:7] op_sel_hi:[1,0,0]
    v_cvt_pk_bf16_f32 v88, v48, v49
    v_cvt_pk_bf16_f32 v89, v50, v51
    v_cvt_pk_bf16_f32 v90, v52, v53
    v_cvt_pk_bf16_f32 v91, v54, v55
    ds_write_b128 v4, v[88:91] offset:16384
    v_pk_fma_f32 v[56:57], v[56:57], v[8:9], v[6:7] op_sel_hi:[1,0,0]
    v_pk_fma_f32 v[58:59], v[58:59], v[8:9], v[6:7] op_sel_hi:[1,0,0]
    v_pk_fma_f32 v[60:61], v[60:61], v[8:9], v[6:7] op_sel_hi:[1,0,0]
    v_pk_fma_f32 v[62:63], v[62:63], v[8:9], v[6:7] op_sel_hi:[1,0,0]
    v_cvt_pk_bf16_f32 v92, v56, v57
    v_cvt_pk_bf16_f32 v93, v58, v59
    v_cvt_pk_bf16_f32 v94, v60, v61
    v_cvt_pk_bf16_f32 v95, v62, v63
    ds_write_b128 v4, v[92:95] offset:20480
    v_pk_fma_f32 v[64:65], v[64:65], v[8:9], v[6:7] op_sel_hi:[1,0,0]
    v_pk_fma_f32 v[66:67], v[66:67], v[8:9], v[6:7] op_sel_hi:[1,0,0]
    v_pk_fma_f32 v[68:69], v[68:69], v[8:9], v[6:7] op_sel_hi:[1,0,0]
    v_pk_fma_f32 v[70:71], v[70:71], v[8:9], v[6:7] op_sel_hi:[1,0,0]
    v_cvt_pk_bf16_f32 v96, v64, v65
    v_cvt_pk_bf16_f32 v97, v66, v67
    v_cvt_pk_bf16_f32 v98, v68, v69
    v_cvt_pk_bf16_f32 v99, v70, v71
    ds_write_b128 v4, v[96:99] offset:24576
    s_cmp_lg_u32 s39, 0
    s_cbranch_scc1 L_P1L
    s_waitcnt vmcnt(3) lgkmcnt(0)
    s_barrier
    ds_read_b128 v[64:67], v10 offset:0
    ds_read_b64_tr_b16 v[68:69], v14 offset:0
    ds_read_b64_tr_b16 v[70:71], v14 offset:512
    ds_read_b64_tr_b16 v[72:73], v14 offset:8192
    ds_read_b64_tr_b16 v[74:75], v14 offset:8704
    ds_read_b64_tr_b16 v[76:77], v112 offset:16384
    ds_read_b64_tr_b16 v[78:79], v112 offset:16896
    ds_read_b128 v[80:83], v11 offset:1024
    ds_read_b64_tr_b16 v[84:85], v14 offset:2048
    ds_read_b64_tr_b16 v[86:87], v14 offset:2560
    ds_read_b64_tr_b16 v[88:89], v14 offset:10240
    ds_read_b64_tr_b16 v[90:91], v14 offset:10752
    ds_read_b64_tr_b16 v[92:93], v112 offset:18432
    ds_read_b64_tr_b16 v[94:95], v112 offset:18944
    s_waitcnt lgkmcnt(7)
    v_mfma_f32_32x32x16_bf16 v[16:31], v[68:71], v[64:67], 0
    ds_read_b128 v[96:99], v12 offset:2048
    ds_read_b64_tr_b16 v[100:101], v14 offset:4096
    v_mfma_f32_32x32x16_bf16 v[32:47], v[72:75], v[64:67], 0
    ds_read_b64_tr_b16 v[102:103], v14 offset:4608
    ds_read_b64_tr_b16 v[104:105], v14 offset:12288
    v_mfma_f32_32x32x16_bf16 v[48:63], v[64:67], v[76:79], 0
    ds_read_b64_tr_b16 v[106:107], v14 offset:12800
    ds_read_b64_tr_b16 v[108:109], v112 offset:20480
    ds_read_b64_tr_b16 v[110:111], v112 offset:20992
    s_waitcnt lgkmcnt(7)
    v_mfma_f32_32x32x16_bf16 v[16:31], v[84:87], v[80:83], v[16:31]
    ds_read_b128 v[64:67], v13 offset:3072
    ds_read_b64_tr_b16 v[68:69], v14 offset:6144
    v_mfma_f32_32x32x16_bf16 v[32:47], v[88:91], v[80:83], v[32:47]
    ds_read_b64_tr_b16 v[70:71], v14 offset:6656
    ds_read_b64_tr_b16 v[72:73], v14 offset:14336
    v_mfma_f32_32x32x16_bf16 v[48:63], v[80:83], v[92:95], v[48:63]
    ds_read_b64_tr_b16 v[74:75], v14 offset:14848
    ds_read_b64_tr_b16 v[76:77], v112 offset:22528
    ds_read_b64_tr_b16 v[78:79], v112 offset:23040
    s_waitcnt vmcnt(0)
    s_barrier
    s_waitcnt lgkmcnt(7)
    v_mfma_f32_32x32x16_bf16 v[16:31], v[100:103], v[96:99], v[16:31]
    ds_read_b128 v[80:83], v10 offset:4096
    ds_read_b64_tr_b16 v[84:85], v14 offset:24576
    v_mfma_f32_32x32x16_bf16 v[32:47], v[104:107], v[96:99], v[32:47]
    ds_read_b64_tr_b16 v[86:87], v14 offset:25088
    ds_read_b64_tr_b16 v[88:89], v14 offset:32768
    v_mfma_f32_32x32x16_bf16 v[48:63], v[96:99], v[108:111], v[48:63]
    ds_read_b64_tr_b16 v[90:91], v14 offset:33280
    ds_read_b64_tr_b16 v[92:93], v112 offset:40960
    ds_read_b64_tr_b16 v[94:95], v112 offset:41472
    s_waitcnt lgkmcnt(7)
    v_mfma_f32_32x32x16_bf16 v[16:31], v[68:71], v[64:67], v[16:31]
    ds_read_b128 v[96:99], v11 offset:5120
    ds_read_b64_tr_b16 v[100:101], v14 offset:26624
    v_mfma_f32_32x32x16_bf16 v[32:47], v[72:75], v[64:67], v[32:47]
    ds_read_b64_tr_b16 v[102:103], v14 offset:27136
    ds_read_b64_tr_b16 v[104:105], v14 offset:34816
    v_mfma_f32_32x32x16_bf16 v[48:63], v[64:67], v[76:79], v[48:63]
    ds_read_b64_tr_b16 v[106:107], v14 offset:35328
    ds_read_b64_tr_b16 v[108:109], v112 offset:43008
    ds_read_b64_tr_b16 v[110:111], v112 offset:43520
    s_waitcnt lgkmcnt(7)
    v_mfma_f32_32x32x16_bf16 v[16:31], v[84:87], v[80:83], v[16:31]
    ds_read_b128 v[64:67], v12 offset:6144
    ds_read_b64_tr_b16 v[68:69], v14 offset:28672
    v_mfma_f32_32x32x16_bf16 v[32:47], v[88:91], v[80:83], v[32:47]
    ds_read_b64_tr_b16 v[70:71], v14 offset:29184
    ds_read_b64_tr_b16 v[72:73], v14 offset:36864
    v_mfma_f32_32x32x16_bf16 v[48:63], v[80:83], v[92:95], v[48:63]
    ds_read_b64_tr_b16 v[74:75], v14 offset:37376
    ds_read_b64_tr_b16 v[76:77], v112 offset:45056
    ds_read_b64_tr_b16 v[78:79], v112 offset:45568
    s_waitcnt lgkmcnt(7)
    v_mfma_f32_32x32x16_bf16 v[16:31], v[100:103], v[96:99], v[16:31]
    ds_read_b128 v[80:83], v13 offset:7168
    ds_read_b64_tr_b16 v[84:85], v14 offset:30720
    v_mfma_f32_32x32x16_bf16 v[32:47], v[104:107], v[96:99], v[32:47]
    ds_read_b64_tr_b16 v[86:87], v14 offset:31232
    ds_read_b64_tr_b16 v[88:89], v14 offset:38912
    v_mfma_f32_32x32x16_bf16 v[48:63], v[96:99], v[108:111], v[48:63]
    ds_read_b64_tr_b16 v[90:91], v14 offset:39424
    ds_read_b64_tr_b16 v[92:93], v112 offset:47104
    ds_read_b64_tr_b16 v[94:95], v112 offset:47616
    s_barrier
    s_waitcnt lgkmcnt(7)
    v_mfma_f32_32x32x16_bf16 v[16:31], v[68:71], v[64:67], v[16:31]
    ds_read_b128 v[96:99], v10 offset:8192
    ds_read_b64_tr_b16 v[100:101], v15 offset:0
    v_mfma_f32_32x32x16_bf16 v[32:47], v[72:75], v[64:67], v[32:47]
    ds_read_b64_tr_b16 v[102:103], v15 offset:512
    ds_read_b64_tr_b16 v[104:105], v15 offset:8192
    v_mfma_f32_32x32x16_bf16 v[48:63], v[64:67], v[76:79], v[48:63]
    ds_read_b64_tr_b16 v[106:107], v15 offset:8704
    ds_read_b64_tr_b16 v[108:109], v113 offset:16384
    ds_read_b64_tr_b16 v[110:111], v113 offset:16896
    s_waitcnt lgkmcnt(7)
    v_mfma_f32_32x32x16_bf16 v[16:31], v[84:87], v[80:83], v[16:31]
    ds_read_b128 v[64:67], v11 offset:9216
    ds_read_b64_tr_b16 v[68:69], v15 offset:2048
    v_mfma_f32_32x32x16_bf16 v[32:47], v[88:91], v[80:83], v[32:47]
    ds_read_b64_tr_b16 v[70:71], v15 offset:2560
    ds_read_b64_tr_b16 v[72:73], v15 offset:10240
    v_mfma_f32_32x32x16_bf16 v[48:63], v[80:83], v[92:95], v[48:63]
    ds_read_b64_tr_b16 v[74:75], v15 offset:10752
    ds_read_b64_tr_b16 v[76:77], v113 offset:18432
    ds_read_b64_tr_b16 v[78:79], v113 offset:18944
    s_waitcnt lgkmcnt(7)
    v_mfma_f32_32x32x16_bf16 v[16:31], v[100:103], v[96:99], v[16:31]
    ds_read_b128 v[80:83], v12 offset:10240
    ds_read_b64_tr_b16 v[84:85], v15 offset:4096
    v_mfma_f32_32x32x16_bf16 v[32:47], v[104:107], v[96:99], v[32:47]
    ds_read_b64_tr_b16 v[86:87], v15 offset:4608
    ds_read_b64_tr_b16 v[88:89], v15 offset:12288
    v_mfma_f32_32x32x16_bf16 v[48:63], v[96:99], v[108:111], v[48:63]
    ds_read_b64_tr_b16 v[90:91], v15 offset:12800
    ds_read_b64_tr_b16 v[92:93], v113 offset:20480
    ds_read_b64_tr_b16 v[94:95], v113 offset:20992
    s_waitcnt lgkmcnt(7)
    v_mfma_f32_32x32x16_bf16 v[16:31], v[68:71], v[64:67], v[16:31]
    ds_read_b128 v[96:99], v13 offset:11264
    ds_read_b64_tr_b16 v[100:101], v15 offset:6144
    v_mfma_f32_32x32x16_bf16 v[32:47], v[72:75], v[64:67], v[32:47]
    ds_read_b64_tr_b16 v[102:103], v15 offset:6656
    ds_read_b64_tr_b16 v[104:105], v15 offset:14336
    v_mfma_f32_32x32x16_bf16 v[48:63], v[64:67], v[76:79], v[48:63]
    ds_read_b64_tr_b16 v[106:107], v15 offset:14848
    ds_read_b64_tr_b16 v[108:109], v113 offset:22528
    ds_read_b64_tr_b16 v[110:111], v113 offset:23040
    s_barrier
    s_waitcnt lgkmcnt(7)
    v_mfma_f32_32x32x16_bf16 v[16:31], v[84:87], v[80:83], v[16:31]
    ds_read_b128 v[64:67], v10 offset:12288
    ds_read_b64_tr_b16 v[68:69], v15 offset:24576
    v_mfma_f32_32x32x16_bf16 v[32:47], v[88:91], v[80:83], v[32:47]
    ds_read_b64_tr_b16 v[70:71], v15 offset:25088
    ds_read_b64_tr_b16 v[72:73], v15 offset:32768
    v_mfma_f32_32x32x16_bf16 v[48:63], v[80:83], v[92:95], v[48:63]
    ds_read_b64_tr_b16 v[74:75], v15 offset:33280
    ds_read_b64_tr_b16 v[76:77], v113 offset:40960
    ds_read_b64_tr_b16 v[78:79], v113 offset:41472
    s_waitcnt lgkmcnt(7)
    v_mfma_f32_32x32x16_bf16 v[16:31], v[100:103], v[96:99], v[16:31]
    ds_read_b128 v[80:83], v11 offset:13312
    ds_read_b64_tr_b16 v[84:85], v15 offset:26624
    v_mfma_f32_32x32x16_bf16 v[32:47], v[104:107], v[96:99], v[32:47]
    ds_read_b64_tr_b16 v[86:87], v15 offset:27136
    ds_read_b64_tr_b16 v[88:89], v15 offset:34816
    v_mfma_f32_32x32x16_bf16 v[48:63], v[96:99], v[108:111], v[48:63]
    ds_read_b64_tr_b16 v[90:91], v15 offset:35328
    ds_read_b64_tr_b16 v[92:93], v113 offset:43008
    ds_read_b64_tr_b16 v[94:95], v113 offset:43520
    s_waitcnt lgkmcnt(7)
    v_mfma_f32_32x32x16_bf16 v[16:31], v[68:71], v[64:67], v[16:31]
    ds_read_b128 v[96:99], v12 offset:14336
    ds_read_b64_tr_b16 v[100:101], v15 offset:28672
    v_mfma_f32_32x32x16_bf16 v[32:47], v[72:75], v[64:67], v[32:47]
    ds_read_b64_tr_b16 v[102:103], v15 offset:29184
    ds_read_b64_tr_b16 v[104:105], v15 offset:36864
    v_mfma_f32_32x32x16_bf16 v[48:63], v[64:67], v[76:79], v[48:63]
    ds_read_b64_tr_b16 v[106:107], v15 offset:37376
    ds_read_b64_tr_b16 v[108:109], v113 offset:45056
    ds_read_b64_tr_b16 v[110:111], v113 offset:45568
    s_waitcnt lgkmcnt(7)
    v_mfma_f32_32x32x16_bf16 v[16:31], v[84:87], v[80:83], v[16:31]
    ds_read_b128 v[64:67], v13 offset:15360
    ds_read_b64_tr_b16 v[68:69], v15 offset:30720
    v_mfma_f32_32x32x16_bf16 v[32:47], v[88:91], v[80:83], v[32:47]
    ds_read_b64_tr_b16 v[70:71], v15 offset:31232
    ds_read_b64_tr_b16 v[72:73], v15 offset:38912
    v_mfma_f32_32x32x16_bf16 v[48:63], v[80:83], v[92:95], v[48:63]
    ds_read_b64_tr_b16 v[74:75], v15 offset:39424
    ds_read_b64_tr_b16 v[76:77], v113 offset:47104
    ds_read_b64_tr_b16 v[78:79], v113 offset:47616
    s_barrier
    s_waitcnt lgkmcnt(7)
    v_mfma_f32_32x32x16_bf16 v[16:31], v[100:103], v[96:99], v[16:31]
    ds_read_b128 v[80:83], v10 offset:16384
    ds_read_b64_tr_b16 v[84:85], v14 offset:0
    v_mfma_f32_32x32x16_bf16 v[32:47], v[104:107], v[96:99], v[32:47]
    ds_read_b64_tr_b16 v[86:87], v14 offset:512
    ds_read_b64_tr_b16 v[88:89], v14 offset:8192
    v_mfma_f32_32x32x16_bf16 v[48:63], v[96:99], v[108:111], v[48:63]
    ds_read_b64_tr_b16 v[90:91], v14 offset:8704
    ds_read_b64_tr_b16 v[92:93], v112 offset:16384
    ds_read_b64_tr_b16 v[94:95], v112 offset:16896
    s_waitcnt lgkmcnt(7)
    v_mfma_f32_32x32x16_bf16 v[16:31], v[68:71], v[64:67], v[16:31]
    ds_read_b128 v[96:99], v11 offset:17408
    ds_read_b64_tr_b16 v[100:101], v14 offset:2048
    v_mfma_f32_32x32x16_bf16 v[32:47], v[72:75], v[64:67], v[32:47]
    ds_read_b64_tr_b16 v[102:103], v14 offset:2560
    ds_read_b64_tr_b16 v[104:105], v14 offset:10240
    v_mfma_f32_32x32x16_bf16 v[48:63], v[64:67], v[76:79], v[48:63]
    ds_read_b64_tr_b16 v[106:107], v14 offset:10752
    ds_read_b64_tr_b16 v[108:109], v112 offset:18432
    ds_read_b64_tr_b16 v[110:111], v112 offset:18944
    s_waitcnt lgkmcnt(7)
    v_mfma_f32_32x32x16_bf16 v[16:31], v[84:87], v[80:83], v[16:31]
    ds_read_b128 v[64:67], v12 offset:18432
    ds_read_b64_tr_b16 v[68:69], v14 offset:4096
    v_mfma_f32_32x32x16_bf16 v[32:47], v[88:91], v[80:83], v[32:47]
    ds_read_b64_tr_b16 v[70:71], v14 offset:4608
    ds_read_b64_tr_b16 v[72:73], v14 offset:12288
    v_mfma_f32_32x32x16_bf16 v[48:63], v[80:83], v[92:95], v[48:63]
    ds_read_b64_tr_b16 v[74:75], v14 offset:12800
    ds_read_b64_tr_b16 v[76:77], v112 offset:20480
    ds_read_b64_tr_b16 v[78:79], v112 offset:20992
    s_waitcnt lgkmcnt(7)
    v_mfma_f32_32x32x16_bf16 v[16:31], v[100:103], v[96:99], v[16:31]
    ds_read_b128 v[80:83], v13 offset:19456
    ds_read_b64_tr_b16 v[84:85], v14 offset:6144
    v_mfma_f32_32x32x16_bf16 v[32:47], v[104:107], v[96:99], v[32:47]
    ds_read_b64_tr_b16 v[86:87], v14 offset:6656
    ds_read_b64_tr_b16 v[88:89], v14 offset:14336
    v_mfma_f32_32x32x16_bf16 v[48:63], v[96:99], v[108:111], v[48:63]
    ds_read_b64_tr_b16 v[90:91], v14 offset:14848
    ds_read_b64_tr_b16 v[92:93], v112 offset:22528
    ds_read_b64_tr_b16 v[94:95], v112 offset:23040
    s_barrier
    s_waitcnt lgkmcnt(7)
    v_mfma_f32_32x32x16_bf16 v[16:31], v[68:71], v[64:67], v[16:31]
    ds_read_b128 v[96:99], v10 offset:20480
    ds_read_b64_tr_b16 v[100:101], v14 offset:24576
    v_mfma_f32_32x32x16_bf16 v[32:47], v[72:75], v[64:67], v[32:47]
    ds_read_b64_tr_b16 v[102:103], v14 offset:25088
    ds_read_b64_tr_b16 v[104:105], v14 offset:32768
    v_mfma_f32_32x32x16_bf16 v[48:63], v[64:67], v[76:79], v[48:63]
    ds_read_b64_tr_b16 v[106:107], v14 offset:33280
    ds_read_b64_tr_b16 v[108:109], v112 offset:40960
    ds_read_b64_tr_b16 v[110:111], v112 offset:41472
    s_waitcnt lgkmcnt(7)
    v_mfma_f32_32x32x16_bf16 v[16:31], v[84:87], v[80:83], v[16:31]
    ds_read_b128 v[64:67], v11 offset:21504
    ds_read_b64_tr_b16 v[68:69], v14 offset:26624
    v_mfma_f32_32x32x16_bf16 v[32:47], v[88:91], v[80:83], v[32:47]
    ds_read_b64_tr_b16 v[70:71], v14 offset:27136
    ds_read_b64_tr_b16 v[72:73], v14 offset:34816
    v_mfma_f32_32x32x16_bf16 v[48:63], v[80:83], v[92:95], v[48:63]
    ds_read_b64_tr_b16 v[74:75], v14 offset:35328
    ds_read_b64_tr_b16 v[76:77], v112 offset:43008
    ds_read_b64_tr_b16 v[78:79], v112 offset:43520
    s_waitcnt lgkmcnt(7)
    v_mfma_f32_32x32x16_bf16 v[16:31], v[100:103], v[96:99], v[16:31]
    ds_read_b128 v[80:83], v12 offset:22528
    ds_read_b64_tr_b16 v[84:85], v14 offset:28672
    v_mfma_f32_32x32x16_bf16 v[32:47], v[104:107], v[96:99], v[32:47]
    ds_read_b64_tr_b16 v[86:87], v14 offset:29184
    ds_read_b64_tr_b16 v[88:89], v14 offset:36864
    v_mfma_f32_32x32x16_bf16 v[48:63], v[96:99], v[108:111], v[48:63]
    ds_read_b64_tr_b16 v[90:91], v14 offset:37376
    ds_read_b64_tr_b16 v[92:93], v112 offset:45056
    ds_read_b64_tr_b16 v[94:95], v112 offset:45568
    s_waitcnt lgkmcnt(7)
    v_mfma_f32_32x32x16_bf16 v[16:31], v[68:71], v[64:67], v[16:31]
    ds_read_b128 v[96:99], v13 offset:23552
    ds_read_b64_tr_b16 v[100:101], v14 offset:30720
    v_mfma_f32_32x32x16_bf16 v[32:47], v[72:75], v[64:67], v[32:47]
    ds_read_b64_tr_b16 v[102:103], v14 offset:31232
    ds_read_b64_tr_b16 v[104:105], v14 offset:38912
    v_mfma_f32_32x32x16_bf16 v[48:63], v[64:67], v[76:79], v[48:63]
    ds_read_b64_tr_b16 v[106:107], v14 offset:39424
    ds_read_b64_tr_b16 v[108:109], v112 offset:47104
    ds_read_b64_tr_b16 v[110:111], v112 offset:47616
    s_barrier
    s_waitcnt lgkmcnt(7)
    v_mfma_f32_32x32x16_bf16 v[16:31], v[84:87], v[80:83], v[16:31]
    ds_read_b128 v[64:67], v10 offset:24576
    ds_read_b64_tr_b16 v[68:69], v15 offset:0
    v_mfma_f32_32x32x16_bf16 v[32:47], v[88:91], v[80:83], v[32:47]
    ds_read_b64_tr_b16 v[70:71], v15 offset:512
    ds_read_b64_tr_b16 v[72:73], v15 offset:8192
    v_mfma_f32_32x32x16_bf16 v[48:63], v[80:83], v[92:95], v[48:63]
    ds_read_b64_tr_b16 v[74:75], v15 offset:8704
    ds_read_b64_tr_b16 v[76:77], v113 offset:16384
    ds_read_b64_tr_b16 v[78:79], v113 offset:16896
    s_waitcnt lgkmcnt(7)
    v_mfma_f32_32x32x16_bf16 v[16:31], v[100:103], v[96:99], v[16:31]
    ds_read_b128 v[80:83], v11 offset:25600
    ds_read_b64_tr_b16 v[84:85], v15 offset:2048
    v_mfma_f32_32x32x16_bf16 v[32:47], v[104:107], v[96:99], v[32:47]
    ds_read_b64_tr_b16 v[86:87], v15 offset:2560
    ds_read_b64_tr_b16 v[88:89], v15 offset:10240
    v_mfma_f32_32x32x16_bf16 v[48:63], v[96:99], v[108:111], v[48:63]
    ds_read_b64_tr_b16 v[90:91], v15 offset:10752
    ds_read_b64_tr_b16 v[92:93], v113 offset:18432
    ds_read_b64_tr_b16 v[94:95], v113 offset:18944
    s_waitcnt lgkmcnt(7)
    v_mfma_f32_32x32x16_bf16 v[16:31], v[68:71], v[64:67], v[16:31]
    ds_read_b128 v[96:99], v12 offset:26624
    ds_read_b64_tr_b16 v[100:101], v15 offset:4096
    v_mfma_f32_32x32x16_bf16 v[32:47], v[72:75], v[64:67], v[32:47]
    ds_read_b64_tr_b16 v[102:103], v15 offset:4608
    ds_read_b64_tr_b16 v[104:105], v15 offset:12288
    v_mfma_f32_32x32x16_bf16 v[48:63], v[64:67], v[76:79], v[48:63]
    ds_read_b64_tr_b16 v[106:107], v15 offset:12800
    ds_read_b64_tr_b16 v[108:109], v113 offset:20480
    ds_read_b64_tr_b16 v[110:111], v113 offset:20992
    s_waitcnt lgkmcnt(7)
    v_mfma_f32_32x32x16_bf16 v[16:31], v[84:87], v[80:83], v[16:31]
    ds_read_b128 v[64:67], v13 offset:27648
    ds_read_b64_tr_b16 v[68:69], v15 offset:6144
    v_mfma_f32_32x32x16_bf16 v[32:47], v[88:91], v[80:83], v[32:47]
    ds_read_b64_tr_b16 v[70:71], v15 offset:6656
    ds_read_b64_tr_b16 v[72:73], v15 offset:14336
    v_mfma_f32_32x32x16_bf16 v[48:63], v[80:83], v[92:95], v[48:63]
    ds_read_b64_tr_b16 v[74:75], v15 offset:14848
    ds_read_b64_tr_b16 v[76:77], v113 offset:22528
    ds_read_b64_tr_b16 v[78:79], v113 offset:23040
    s_waitcnt lgkmcnt(7)
    v_mfma_f32_32x32x16_bf16 v[16:31], v[100:103], v[96:99], v[16:31]
    v_mfma_f32_32x32x16_bf16 v[32:47], v[104:107], v[96:99], v[32:47]
    v_mfma_f32_32x32x16_bf16 v[48:63], v[96:99], v[108:111], v[48:63]
    s_waitcnt lgkmcnt(0)
    v_mfma_f32_32x32x16_bf16 v[16:31], v[68:71], v[64:67], v[16:31]
    v_mfma_f32_32x32x16_bf16 v[32:47], v[72:75], v[64:67], v[32:47]
    v_mfma_f32_32x32x16_bf16 v[48:63], v[64:67], v[76:79], v[48:63]
    s_lshl_b32 s42, s40, 1
    s_add_u32 s42, s42, s44
    s_mul_i32 s42, s42, 28672
    s_lshl_b32 s43, s41, 1
    s_add_u32 s43, s43, s45
    s_lshl_b32 s46, s43, 11
    s_add_u32 s46, s46, s42
    s_add_u32 s47, s46, 1835008
    s_lshl_b32 s48, s43, 9
    s_add_u32 s48, s48, s42
    s_add_u32 s48, s48, 3670016
    s_add_u32 s49, s48, 14336
    v_mul_u32_u24 v5, 7168, v1
    v_lshl_add_u32 v5, v2, 4, v5
    s_mov_b32 s50, 1049335798
    s_mov_b32 s51, s50
    v_cvt_pk_bf16_f32 v72, v32, v33
    v_cvt_pk_bf16_f32 v73, v34, v35
    v_cvt_pk_bf16_f32 v74, v36, v37
    v_cvt_pk_bf16_f32 v75, v38, v39
    buffer_store_dwordx4 v[72:75], v3, s[24:27], s46 offen offset:0 sc1
    v_cvt_pk_bf16_f32 v76, v40, v41
    v_cvt_pk_bf16_f32 v77, v42, v43
    v_cvt_pk_bf16_f32 v78, v44, v45
    v_cvt_pk_bf16_f32 v79, v46, v47
    buffer_store_dwordx4 v[76:79], v3, s[24:27], s46 offen offset:1024 sc1
    v_cvt_pk_bf16_f32 v80, v48, v49
    v_cvt_pk_bf16_f32 v81, v50, v51
    v_cvt_pk_bf16_f32 v82, v52, v53
    v_cvt_pk_bf16_f32 v83, v54, v55
    buffer_store_dwordx4 v[80:83], v5, s[24:27], s48 offen sc1
    v_cvt_pk_bf16_f32 v84, v56, v57
    v_cvt_pk_bf16_f32 v85, v58, v59
    v_cvt_pk_bf16_f32 v86, v60, v61
    v_cvt_pk_bf16_f32 v87, v62, v63
    buffer_store_dwordx4 v[84:87], v5, s[24:27], s49 offen sc1
    v_pk_mul_f32 v[16:17], v[16:17], s[50:51]
    v_pk_mul_f32 v[18:19], v[18:19], s[50:51]
    v_pk_mul_f32 v[20:21], v[20:21], s[50:51]
    v_pk_mul_f32 v[22:23], v[22:23], s[50:51]
    v_pk_mul_f32 v[24:25], v[24:25], s[50:51]
    v_pk_mul_f32 v[26:27], v[26:27], s[50:51]
    v_pk_mul_f32 v[28:29], v[28:29], s[50:51]
    v_pk_mul_f32 v[30:31], v[30:31], s[50:51]
    v_cvt_pk_bf16_f32 v64, v16, v17
    v_cvt_pk_bf16_f32 v65, v18, v19
    v_cvt_pk_bf16_f32 v66, v20, v21
    v_cvt_pk_bf16_f32 v67, v22, v23
    buffer_store_dwordx4 v[64:67], v3, s[24:27], s47 offen offset:0 sc1
    v_cvt_pk_bf16_f32 v68, v24, v25
    v_cvt_pk_bf16_f32 v69, v26, v27
    v_cvt_pk_bf16_f32 v70, v28, v29
    v_cvt_pk_bf16_f32 v71, v30, v31
    buffer_store_dwordx4 v[68:71], v3, s[24:27], s47 offen offset:1024 sc1
    s_branch L_S1
L_P1L:
    s_mul_i32 s42, s38, 43008
    s_lshl_b32 s43, s41, 7
    s_add_u32 s42, s42, s43
    s_lshl_b32 s43, s38, 11
    s_add_u32 s43, s43, 57344
    s_waitcnt vmcnt(3) lgkmcnt(0)
    s_barrier
    s_add_u32 m0, s43, 49152
    s_add_u32 s44, s42, 344064
    buffer_load_dwordx4 v114, s[32:35], s44 offen lds
    s_add_u32 m0, s43, 50176
    s_add_u32 s44, s42, 365568
    buffer_load_dwordx4 v114, s[32:35], s44 offen lds
    s_add_u32 m0, s43, 57344
    s_add_u32 s44, s42, 344960
    buffer_load_dwordx4 v114, s[32:35], s44 offen lds
    s_add_u32 m0, s43, 58368
    s_add_u32 s44, s42, 366464
    buffer_load_dwordx4 v114, s[32:35], s44 offen lds
    s_add_u32 m0, s43, 65536
    s_add_u32 s44, s42, 345856
    buffer_load_dwordx4 v114, s[32:35], s44 offen lds
    s_add_u32 m0, s43, 66560
    s_add_u32 s44, s42, 367360
    buffer_load_dwordx4 v114, s[32:35], s44 offen lds
    s_add_u32 m0, s43, 73728
    s_add_u32 s44, s42, 516096
    buffer_load_dwordx4 v114, s[32:35], s44 offen lds
    s_add_u32 m0, s43, 74752
    s_add_u32 s44, s42, 537600
    buffer_load_dwordx4 v114, s[32:35], s44 offen lds
    s_add_u32 m0, s43, 81920
    s_add_u32 s44, s42, 516992
    buffer_load_dwordx4 v114, s[32:35], s44 offen lds
    s_add_u32 m0, s43, 82944
    s_add_u32 s44, s42, 538496
    buffer_load_dwordx4 v114, s[32:35], s44 offen lds
    s_add_u32 m0, s43, 90112
    s_add_u32 s44, s42, 517888
    buffer_load_dwordx4 v114, s[32:35], s44 offen lds
    s_add_u32 m0, s43, 91136
    s_add_u32 s44, s42, 539392
    buffer_load_dwordx4 v114, s[32:35], s44 offen lds
    s_waitcnt vmcnt(12) lgkmcnt(0)
    s_barrier
    s_waitcnt vmcnt(6) lgkmcnt(0)
    s_barrier
    s_add_u32 m0, s43, 0
    s_add_u32 s44, s42, 688128
    buffer_load_dwordx4 v114, s[32:35], s44 offen lds
    s_add_u32 m0, s43, 1024
    s_add_u32 s44, s42, 709632
    buffer_load_dwordx4 v114, s[32:35], s44 offen lds
    s_add_u32 m0, s43, 8192
    s_add_u32 s44, s42, 689024
    buffer_load_dwordx4 v114, s[32:35], s44 offen lds
    s_add_u32 m0, s43, 9216
    s_add_u32 s44, s42, 710528
    buffer_load_dwordx4 v114, s[32:35], s44 offen lds
    s_add_u32 m0, s43, 16384
    s_add_u32 s44, s42, 689920
    buffer_load_dwordx4 v114, s[32:35], s44 offen lds
    s_add_u32 m0, s43, 17408
    s_add_u32 s44, s42, 711424
    buffer_load_dwordx4 v114, s[32:35], s44 offen lds
    s_waitcnt vmcnt(6) lgkmcnt(0)
    s_barrier
    s_add_u32 m0, s43, 24576
    s_add_u32 s44, s42, 860160
    buffer_load_dwordx4 v114, s[32:35], s44 offen lds
    s_add_u32 m0, s43, 25600
    s_add_u32 s44, s42, 881664
    buffer_load_dwordx4 v114, s[32:35], s44 offen lds
    s_add_u32 m0, s43, 32768
    s_add_u32 s44, s42, 861056
    buffer_load_dwordx4 v114, s[32:35], s44 offen lds
    s_add_u32 m0, s43, 33792
    s_add_u32 s44, s42, 882560
    buffer_load_dwordx4 v114, s[32:35], s44 offen lds
    s_add_u32 m0, s43, 40960
    s_add_u32 s44, s42, 861952
    buffer_load_dwordx4 v114, s[32:35], s44 offen lds
    s_add_u32 m0, s43, 41984
    s_add_u32 s44, s42, 883456
    buffer_load_dwordx4 v114, s[32:35], s44 offen lds
    s_waitcnt vmcnt(6) lgkmcnt(0)
    s_barrier
    s_add_u32 m0, s43, 49152
    s_add_u32 s44, s42, 1032192
    buffer_load_dwordx4 v114, s[32:35], s44 offen lds
    s_add_u32 m0, s43, 50176
    s_add_u32 s44, s42, 1053696
    buffer_load_dwordx4 v114, s[32:35], s44 offen lds
    s_add_u32 m0, s43, 57344
    s_add_u32 s44, s42, 1033088
    buffer_load_dwordx4 v114, s[32:35], s44 offen lds
    s_add_u32 m0, s43, 58368
    s_add_u32 s44, s42, 1054592
    buffer_load_dwordx4 v114, s[32:35], s44 offen lds
    s_add_u32 m0, s43, 65536
    s_add_u32 s44, s42, 1033984
    buffer_load_dwordx4 v114, s[32:35], s44 offen lds
    s_add_u32 m0, s43, 66560
    s_add_u32 s44, s42, 1055488
    buffer_load_dwordx4 v114, s[32:35], s44 offen lds
    s_waitcnt vmcnt(6) lgkmcnt(0)
    s_barrier
    s_waitcnt vmcnt(0) lgkmcnt(0)
    s_barrier
    s_branch L_S1
L_T:
    s_cmp_ge_u32 s2, 252
    s_cbranch_scc1 L_IDLE
    s_sub_u32 s40, s2, 224
    s_cmp_ge_u32 s40, 14
    s_cselect_b32 s51, 1, 0
    s_mul_i32 s41, s51, 14
    s_sub_u32 s40, s40, s41
    s_and_b32 s41, s3, 1
    s_cmp_eq_u32 s41, 0
    s_cselect_b32 s28, s12, s14
    s_cselect_b32 s29, s13, s15
    s_mov_b32 s30, 1605632
    s_mov_b32 s31, 0x20000
    v_lshrrev_b32 v6, 4, v0
    v_lshl_add_u32 v7, v6, 1, s41
    v_lshlrev_b32 v7, 1, v7
    v_and_b32 v8, 15, v0
    v_xor_b32 v7, v7, v8
    v_mul_u32_u24 v6, 3584, v6
    v_lshl_add_u32 v4, v7, 4, v6
    s_lshr_b32 s42, s3, 1
    s_mul_i32 s49, s42, 14336
    s_lshl_b32 s44, s40, 8
    s_add_u32 s49, s49, s44
    s_mul_i32 s44, s51, 802816
    s_add_u32 s49, s49, s44
    s_lshl_b32 s48, s42, 10
    s_mul_i32 s44, s41, 57344
    s_add_u32 s48, s48, s44
    s_add_u32 m0, s48, 0
    s_add_u32 s50, s49, 0
    buffer_load_dwordx4 v4, s[28:31], s50 offen lds
    s_add_u32 m0, s48, 4096
    s_add_u32 s50, s49, 57344
    buffer_load_dwordx4 v4, s[28:31], s50 offen lds
    s_add_u32 m0, s48, 8192
    s_add_u32 s50, s49, 114688
    buffer_load_dwordx4 v4, s[28:31], s50 offen lds
    s_add_u32 m0, s48, 12288
    s_add_u32 s50, s49, 172032
    buffer_load_dwordx4 v4, s[28:31], s50 offen lds
    s_add_u32 m0, s48, 16384
    s_add_u32 s50, s49, 229376
    buffer_load_dwordx4 v4, s[28:31], s50 offen lds
    s_add_u32 m0, s48, 20480
    s_add_u32 s50, s49, 286720
    buffer_load_dwordx4 v4, s[28:31], s50 offen lds
    s_barrier
    s_add_u32 m0, s48, 24576
    s_add_u32 s50, s49, 344064
    buffer_load_dwordx4 v4, s[28:31], s50 offen lds
    s_add_u32 m0, s48, 28672
    s_add_u32 s50, s49, 401408
    buffer_load_dwordx4 v4, s[28:31], s50 offen lds
    s_add_u32 m0, s48, 32768
    s_add_u32 s50, s49, 458752
    buffer_load_dwordx4 v4, s[28:31], s50 offen lds
    s_add_u32 m0, s48, 36864
    s_add_u32 s50, s49, 516096
    buffer_load_dwordx4 v4, s[28:31], s50 offen lds
    s_add_u32 m0, s48, 40960
    s_add_u32 s50, s49, 573440
    buffer_load_dwordx4 v4, s[28:31], s50 offen lds
    s_add_u32 m0, s48, 45056
    s_add_u32 s50, s49, 630784
    buffer_load_dwordx4 v4, s[28:31], s50 offen lds
    s_add_u32 m0, s48, 49152
    s_add_u32 s50, s49, 688128
    buffer_load_dwordx4 v4, s[28:31], s50 offen lds
    s_add_u32 m0, s48, 53248
    s_add_u32 s50, s49, 745472
    buffer_load_dwordx4 v4, s[28:31], s50 offen lds
    v_bfe_u32 v5, v0, 2, 2
    v_bfe_u32 v6, v0, 1, 1
    v_lshl_add_u32 v7, v1, 4, v5
    v_lshlrev_b32 v7, 8, v7
    v_mul_u32_u24 v8, 57344, v6
    v_add_u32 v7, v7, v8
    v_and_b32 v8, 1, v0
    v_lshl_add_u32 v7, v8, 4, v7
    v_bfe_u32 v8, v0, 4, 1
    v_lshl_add_u32 v7, v8, 3, v7
    v_lshl_add_u32 v5, v5, 1, v6
    v_xor_b32 v5, s3, v5
    v_lshl_add_u32 v7, v5, 5, v7
    s_lshl_b32 s42, s40, 3
    s_add_u32 s42, s42, s3
    s_mul_i32 s43, s42, 9363
    s_lshr_b32 s43, s43, 16
    s_mul_i32 s44, s43, 7
    s_sub_u32 s44, s42, s44
    s_mul_i32 s43, s43, 207872
    s_mul_i32 s45, s44, 29
    s_mov_b32 s46, 1024
    s_add_u32 s47, s44, 84
    s_cmp_lt_u32 s44, 5
    s_cselect_b32 s45, s47, s45
    s_cselect_b32 s46, 2048, s46
    s_cmp_lt_u32 s44, 3
    s_cselect_b32 s45, s44, s45
    s_cselect_b32 s46, 3072, s46
    s_lshl_b32 s45, s45, 10
    s_add_u32 s43, s43, s45
    s_add_u32 s43, s43, 17039360
    s_mul_i32 s45, s46, 28
    s_add_u32 s45, s45, s43
    s_lshl_b32 s47, s51, 9
    s_add_u32 s45, s45, s47
    s_mul_i32 s44, s46, 14
    s_mul_i32 s44, s44, s51
    s_add_u32 s43, s43, s44
    v_mov_b32 v8, 0x3f803f80
    v_mov_b32 v9, v8
    v_mov_b32 v10, v8
    v_mov_b32 v11, v8
    s_waitcnt vmcnt(8)
    s_barrier
    ds_read_b64_tr_b16 v[32:33], v7 offset:0
    ds_read_b64_tr_b16 v[34:35], v7 offset:1024
    ds_read_b64_tr_b16 v[36:37], v7 offset:2048
    ds_read_b64_tr_b16 v[38:39], v7 offset:3072
    ds_read_b64_tr_b16 v[40:41], v7 offset:8192
    ds_read_b64_tr_b16 v[42:43], v7 offset:9216
    ds_read_b64_tr_b16 v[44:45], v7 offset:10240
    ds_read_b64_tr_b16 v[46:47], v7 offset:11264
    ds_read_b64_tr_b16 v[48:49], v7 offset:16384
    ds_read_b64_tr_b16 v[50:51], v7 offset:17408
    ds_read_b64_tr_b16 v[52:53], v7 offset:18432
    ds_read_b64_tr_b16 v[54:55], v7 offset:19456
    s_waitcnt lgkmcnt(10)
    buffer_store_dwordx4 v[32:35], v3, s[24:27], s43 offen sc1
    s_add_u32 s43, s43, s46
    v_mfma_f32_32x32x16_bf16 v[16:31], v[8:11], v[32:35], 0
    s_waitcnt lgkmcnt(8)
    buffer_store_dwordx4 v[36:39], v3, s[24:27], s43 offen sc1
    s_add_u32 s43, s43, s46
    v_mfma_f32_32x32x16_bf16 v[16:31], v[8:11], v[36:39], v[16:31]
    s_waitcnt lgkmcnt(6)
    buffer_store_dwordx4 v[40:43], v3, s[24:27], s43 offen sc1
    s_add_u32 s43, s43, s46
    v_mfma_f32_32x32x16_bf16 v[16:31], v[8:11], v[40:43], v[16:31]
    s_waitcnt lgkmcnt(4)
    buffer_store_dwordx4 v[44:47], v3, s[24:27], s43 offen sc1
    s_add_u32 s43, s43, s46
    v_mfma_f32_32x32x16_bf16 v[16:31], v[8:11], v[44:47], v[16:31]
    s_waitcnt lgkmcnt(2)
    buffer_store_dwordx4 v[48:51], v3, s[24:27], s43 offen sc1
    s_add_u32 s43, s43, s46
    v_mfma_f32_32x32x16_bf16 v[16:31], v[8:11], v[48:51], v[16:31]
    s_waitcnt lgkmcnt(0)
    buffer_store_dwordx4 v[52:55], v3, s[24:27], s43 offen sc1
    s_add_u32 s43, s43, s46
    v_mfma_f32_32x32x16_bf16 v[16:31], v[8:11], v[52:55], v[16:31]
    s_waitcnt vmcnt(10)
    s_barrier
    ds_read_b64_tr_b16 v[56:57], v7 offset:24576
    ds_read_b64_tr_b16 v[58:59], v7 offset:25600
    ds_read_b64_tr_b16 v[60:61], v7 offset:26624
    ds_read_b64_tr_b16 v[62:63], v7 offset:27648
    ds_read_b64_tr_b16 v[64:65], v7 offset:32768
    ds_read_b64_tr_b16 v[66:67], v7 offset:33792
    ds_read_b64_tr_b16 v[68:69], v7 offset:34816
    ds_read_b64_tr_b16 v[70:71], v7 offset:35840
    s_waitcnt lgkmcnt(6)
    buffer_store_dwordx4 v[56:59], v3, s[24:27], s43 offen sc1
    s_add_u32 s43, s43, s46
    v_mfma_f32_32x32x16_bf16 v[16:31], v[8:11], v[56:59], v[16:31]
    s_waitcnt lgkmcnt(4)
    buffer_store_dwordx4 v[60:63], v3, s[24:27], s43 offen sc1
    s_add_u32 s43, s43, s46
    v_mfma_f32_32x32x16_bf16 v[16:31], v[8:11], v[60:63], v[16:31]
    s_waitcnt lgkmcnt(2)
    buffer_store_dwordx4 v[64:67], v3, s[24:27], s43 offen sc1
    s_add_u32 s43, s43, s46
    v_mfma_f32_32x32x16_bf16 v[16:31], v[8:11], v[64:67], v[16:31]
    s_waitcnt lgkmcnt(0)
    buffer_store_dwordx4 v[68:71], v3, s[24:27], s43 offen sc1
    s_add_u32 s43, s43, s46
    v_mfma_f32_32x32x16_bf16 v[16:31], v[8:11], v[68:71], v[16:31]
    s_waitcnt vmcnt(10)
    s_barrier
    ds_read_b64_tr_b16 v[72:73], v7 offset:40960
    ds_read_b64_tr_b16 v[74:75], v7 offset:41984
    ds_read_b64_tr_b16 v[76:77], v7 offset:43008
    ds_read_b64_tr_b16 v[78:79], v7 offset:44032
    ds_read_b64_tr_b16 v[80:81], v7 offset:49152
    ds_read_b64_tr_b16 v[82:83], v7 offset:50176
    ds_read_b64_tr_b16 v[84:85], v7 offset:51200
    ds_read_b64_tr_b16 v[86:87], v7 offset:52224
    s_waitcnt lgkmcnt(6)
    buffer_store_dwordx4 v[72:75], v3, s[24:27], s43 offen sc1
    s_add_u32 s43, s43, s46
    v_mfma_f32_32x32x16_bf16 v[16:31], v[8:11], v[72:75], v[16:31]
    s_waitcnt lgkmcnt(4)
    buffer_store_dwordx4 v[76:79], v3, s[24:27], s43 offen sc1
    s_add_u32 s43, s43, s46
    v_mfma_f32_32x32x16_bf16 v[16:31], v[8:11], v[76:79], v[16:31]
    s_waitcnt lgkmcnt(2)
    buffer_store_dwordx4 v[80:83], v3, s[24:27], s43 offen sc1
    s_add_u32 s43, s43, s46
    v_mfma_f32_32x32x16_bf16 v[16:31], v[8:11], v[80:83], v[16:31]
    s_waitcnt lgkmcnt(0)
    buffer_store_dwordx4 v[84:87], v3, s[24:27], s43 offen sc1
    s_add_u32 s43, s43, s46
    v_mfma_f32_32x32x16_bf16 v[16:31], v[8:11], v[84:87], v[16:31]
    v_mov_b32 v13, 0
    v_mov_b32 v14, 0
    v_mov_b32 v15, 0
    s_nop 8
    v_cvt_pk_bf16_f32 v12, v16, v16
    v_lshlrev_b32 v12, 16, v12
    v_sub_f32 v12, v16, v12
    v_cvt_pk_bf16_f32 v12, v16, v12
    s_mov_b32 exec_hi, 0
    buffer_store_dwordx4 v[12:15], v3, s[24:27], s45 offen sc1
    s_mov_b64 exec, -1
    s_branch L_S1
L_IDLE:
    s_cmp_lg_u32 s2, 255
    s_cbranch_scc1 L_S1
    s_cmp_lg_u32 s3, 0
    s_cbranch_scc1 L_S1
    v_lshlrev_b32 v4, 7, v0
    v_mov_b32 v5, 0
    s_mov_b32 s41, 20512768
    buffer_load_dword v6, off, s[24:27], s41 sc1
    s_mov_b32 s40, 20447232
    buffer_store_dword v5, v4, s[24:27], s40 offen sc1
    s_mov_b32 s40, 20455424
    buffer_store_dword v5, v4, s[24:27], s40 offen sc1
    s_mov_b32 s40, 20463616
    buffer_store_dword v5, v4, s[24:27], s40 offen sc1
    s_mov_b32 s40, 20471808
    buffer_store_dword v5, v4, s[24:27], s40 offen sc1
    s_mov_b32 s40, 20480000
    buffer_store_dword v5, v4, s[24:27], s40 offen sc1
    s_mov_b32 s40, 20488192
    buffer_store_dword v5, v4, s[24:27], s40 offen sc1
    s_mov_b32 s40, 20496384
    buffer_store_dword v5, v4, s[24:27], s40 offen sc1
    s_mov_b32 s40, 20504576
    buffer_store_dword v5, v4, s[24:27], s40 offen sc1
    s_mov_b32 s28, s20
    s_mov_b32 s29, s21
    s_mov_b32 s30, 256
    s_mov_b32 s31, 0x20000
    s_waitcnt vmcnt(0)
    v_add_u32 v5, 16, v6
    v_and_b32 v5, 0x7ffffff0, v5
    v_max_u32 v5, 16, v5
    s_mov_b64 exec, 1
    buffer_store_dword v5, off, s[28:31], 0 sc1
    buffer_store_dword v5, off, s[24:27], s41 sc1
    s_mov_b64 exec, -1
L_S1:
    s_mov_b32 s32, s20
    s_mov_b32 s33, s21
    s_mov_b32 s34, 256
    s_mov_b32 s35, 0x20000
    buffer_load_dword v9, off, s[32:35], 0 sc1
    s_lshl_b32 s40, s36, 1
    s_and_b32 s41, s37, 1
    s_add_u32 s40, s40, s41
    s_lshr_b32 s41, s37, 1
    s_lshl_b32 s42, s41, 2
    s_add_u32 s42, s42, s38
    s_mul_i32 s43, s42, 28672
    s_mul_i32 s44, s40, 7
    s_lshr_b32 s44, s44, 1
    s_lshl_b32 s44, s44, 9
    s_add_u32 s43, s43, s44
    s_add_u32 s43, s43, 1835008
    s_and_b32 s45, s38, 1
    s_lshl_b32 s46, s45, 10
    s_add_u32 s46, s46, s44
    s_mul_i32 s45, s45, 14336
    s_mul_i32 s47, s40, 448
    s_add_u32 s45, s45, s47
    s_add_u32 s45, s45, 3670016
    s_cmp_lt_u32 s38, 2
    s_cselect_b32 s45, s46, s45
    s_cselect_b32 s48, -1, 0x0fffffff
    s_mov_b32 s46, 7168
    s_cselect_b32 s46, 512, s46
    s_mov_b32 s49, s48
    s_mul_i32 s47, s39, 917504
    s_add_u32 s45, s45, s47
    s_lshl_b32 s47, s3, 10
    v_mul_u32_u24 v11, s46, v1
    v_lshl_add_u32 v11, v2, 4, v11
    s_mov_b32 s50, 0
    s_lshr_b32 s51, s44, 6
    s_add_u32 s52, s51, 31
    s_lshr_b32 s52, s52, 6
    s_lshr_b32 s51, s51, 6
    s_sub_u32 s52, s52, s51
    v_mul_lo_u32 v4, v1, s52
    v_add_u32 v4, s51, v4
    v_and_b32 v5, 3, v2
    v_lshl_add_u32 v4, v4, 2, v5
    v_lshrrev_b32 v5, 2, v2
    v_lshl_add_u32 v4, v4, 3, v5
    v_lshlrev_b32 v4, 7, v4
    v_lshlrev_b32 v10, 3, v0
    s_lshl_b32 s51, s39, 12
    v_add_u32 v13, s51, v3
    v_add_u32 v14, 0x10000, v13
    v_lshrrev_b32 v6, 3, v0
    v_bfe_u32 v7, v0, 4, 1
    v_lshlrev_b32 v7, 2, v7
    v_and_b32 v8, 7, v0
    v_xor_b32 v7, v7, v8
    v_mul_u32_u24 v6, 896, v6
    v_lshl_add_u32 v15, v7, 4, v6
    s_waitcnt vmcnt(0)
    s_barrier
    s_cmp_lg_u32 s3, 0
    s_cbranch_scc1 L_nw0_4
    s_mov_b32 s58, 0x100000
L_rdy_5:
    v_cmp_ne_u32 vcc, 0, v9
    s_sub_u32 s58, s58, 1
    s_cbranch_vccnz L_rdyd_6
    s_cmp_eq_u32 s58, 0
    s_cbranch_scc1 L_rdyd_6
    buffer_load_dword v9, off, s[32:35], 0 sc1
    s_waitcnt vmcnt(0)
    s_branch L_rdy_5
L_rdyd_6:
    v_readfirstlane_b32 s97, v9
    s_lshl_b32 s58, s2, 7
    s_add_u32 s58, s58, 20447232
    v_mov_b32 v5, 1
    s_mov_b64 exec, 1
    buffer_store_dword v5, off, s[24:27], s58 sc1
    s_mov_b64 exec, -1
L_nw0_4:
    v_mov_b32 v16, 0x3f803f80
    v_mov_b32 v17, v16
    v_mov_b32 v18, v16
    v_mov_b32 v19, v16
    v_and_b32 v6, 3, v0
    v_lshlrev_b32 v6, 4, v6
    v_bfe_u32 v7, v0, 2, 2
    v_lshl_add_u32 v6, v7, 9, v6
    v_lshrrev_b32 v7, 4, v0
    v_lshl_add_u32 v6, v7, 12, v6
    s_lshl_b32 s51, s3, 14
    v_add_u32 v6, s51, v6
    ds_write_b128 v6, v[16:19] offset:2496
    v_mov_b32 v20, 0
    v_mov_b32 v6, 153600
    ds_write_b32 v6, v20
    s_lshr_b32 s52, s37, 2
    s_lshl_b32 s53, s52, 7
    s_mul_i32 s54, s3, 7168
    s_add_u32 s53, s53, s54
    s_lshl_b32 s55, s36, 2
    s_and_b32 s56, s37, 3
    s_add_u32 s55, s55, s56
    s_lshl_b32 s55, s55, 1
    s_and_b32 s56, s3, 1
    s_add_u32 s55, s55, s56
    s_mul_i32 s55, s55, 28672
    s_lshl_b32 s52, s52, 1
    s_bfe_u32 s56, s3, 0x10001
    s_add_u32 s52, s52, s56
    s_lshl_b32 s52, s52, 6
    s_add_u32 s55, s55, s52
    v_mul_u32_u24 v128, 896, v2
    v_lshl_add_u32 v128, v1, 5, v128
    s_lshr_b32 s52, s37, 1
    s_mul_i32 s52, s52, 7
    s_add_u32 s56, s52, 6
    s_lshr_b32 s52, s52, 3
    s_lshr_b32 s56, s56, 3
    v_add_u32 v129, s52, v2
    v_min_u32 v129, s56, v129
    v_mad_u32_u24 v129, v1, 14, v129
    v_add_u32 v129, 224, v129
    v_lshlrev_b32 v129, 7, v129
    s_mov_b32 s56, 20447232
    s_lshl_b32 s57, s2, 3
    s_add_u32 s57, s57, s3
    s_lshl_b32 s57, s57, 10
    v_mov_b32 v130, 0
    v_mov_b32 v131, 0
    s_lshr_b32 s54, s37, 1
    s_mul_i32 s54, s54, 207872
    s_add_u32 s54, s54, 17039360
    s_lshl_b32 s52, s38, 11
    s_add_u32 s46, s54, s52
    s_add_u32 s46, s46, 200704
    s_mul_i32 s52, s38, 7168
    s_add_u32 s54, s54, s52
    s_mul_i32 s52, s39, 86016
    s_add_u32 s54, s54, s52
    s_mov_b32 s28, s8
    s_mov_b32 s29, s9
    s_mov_b32 s30, 401408
    s_mov_b32 s31, 0x20000
    s_cmp_lg_u32 s3, 0
    s_cbranch_scc1 L_j1_7
    s_mov_b32 s58, 0x100000
    s_mov_b32 s59, 20447232
L_poll_8:
    buffer_load_dword v5, v4, s[24:27], s59 offen sc1
    s_sub_u32 s58, s58, 1
    s_cmp_eq_u32 s58, 0
    s_cbranch_scc1 L_polld_9
    s_waitcnt vmcnt(0)
    v_cmp_gt_u32 vcc, 1, v5
    s_nop 0
    s_cbranch_vccnz L_poll_8
L_polld_9:
L_j1_7:
    s_waitcnt lgkmcnt(0)
    s_barrier
L_top_10:
    s_add_u32 m0, s47, 0
    s_add_u32 s51, s45, 0
    s_mov_b64 exec, s[48:49]
    buffer_load_dwordx4 v11, s[24:27], s51 offen sc1 lds
    s_mov_b64 exec, -1
    s_add_u32 m0, s47, 8192
    s_add_u32 s51, s45, 28672
    s_mov_b64 exec, s[48:49]
    buffer_load_dwordx4 v11, s[24:27], s51 offen sc1 lds
    s_mov_b64 exec, -1
    buffer_load_dwordx4 v[112:115], v3, s[24:27], s43 offen offset:0 sc1
    buffer_load_dwordx4 v[116:119], v3, s[24:27], s43 offen offset:1024 sc1
    s_barrier
    s_add_u32 m0, s47, 16384
    s_add_u32 s51, s45, 57344
    s_mov_b64 exec, s[48:49]
    buffer_load_dwordx4 v11, s[24:27], s51 offen sc1 lds
    s_mov_b64 exec, -1
    s_add_u32 m0, s47, 24576
    s_add_u32 s51, s45, 86016
    s_mov_b64 exec, s[48:49]
    buffer_load_dwordx4 v11, s[24:27], s51 offen sc1 lds
    s_mov_b64 exec, -1
    s_add_u32 m0, s47, 32768
    s_add_u32 s51, s45, 114688
    s_mov_b64 exec, s[48:49]
    buffer_load_dwordx4 v11, s[24:27], s51 offen sc1 lds
    s_mov_b64 exec, -1
    s_and_b32 s51, s40, 1
    s_lshl_b32 s51, s51, 5
    v_cmp_le_u32 s[58:59], s51, v0
    s_add_u32 s51, s51, 32
    v_cmp_gt_u32 vcc, s51, v0
    s_waitcnt vmcnt(3)
    s_barrier
    v_cndmask_b32 v112, 0, v112, s[58:59]
    v_cndmask_b32 v113, 0, v113, s[58:59]
    v_cndmask_b32 v118, 0, v118, vcc
    v_cndmask_b32 v119, 0, v119, vcc
    ds_read_b128 v[136:139], v3
    ds_read_b128 v[140:143], v3 offset:1024
    ds_read_b128 v[72:75], v13 offset:0
    ds_read_b128 v[76:79], v13 offset:1024
    ds_read_b128 v[80:83], v13 offset:8192
    ds_read_b128 v[84:87], v13 offset:9216
    ds_read_b128 v[88:91], v13 offset:2048
    ds_read_b128 v[92:95], v13 offset:3072
    s_add_u32 m0, s47, 40960
    s_add_u32 s51, s45, 143360
    s_mov_b64 exec, s[48:49]
    buffer_load_dwordx4 v11, s[24:27], s51 offen sc1 lds
    s_mov_b64 exec, -1
    s_waitcnt lgkmcnt(6)
    v_mfma_f32_32x32x16_bf16 v[32:47], v[136:139], v[112:115], 0
    v_mfma_f32_32x32x16_bf16 v[32:47], v[140:143], v[116:119], v[32:47]
    s_add_u32 m0, s47, 49152
    s_add_u32 s51, s45, 172032
    s_mov_b64 exec, s[48:49]
    buffer_load_dwordx4 v11, s[24:27], s51 offen sc1 lds
    s_mov_b64 exec, -1
    s_add_u32 m0, s47, 57344
    s_add_u32 s51, s45, 200704
    s_mov_b64 exec, s[48:49]
    buffer_load_dwordx4 v11, s[24:27], s51 offen sc1 lds
    s_mov_b64 exec, -1
    s_cmp_lg_u32 s50, 0
    s_cbranch_scc1 L_nomax_11
    s_nop 0
    v_max3_f32 v6, v32, v33, v34
    v_max3_f32 v6, v6, v35, v36
    v_max3_f32 v6, v6, v37, v38
    v_max3_f32 v6, v6, v39, v40
    v_max3_f32 v6, v6, v41, v42
    v_max3_f32 v6, v6, v43, v44
    v_max3_f32 v6, v6, v45, v46
    v_max_f32 v6, v6, v47
    v_mov_b32 v7, v6
    s_nop 1
    v_permlane32_swap_b32 v6, v7
    s_nop 1
    v_max_f32 v6, v6, v7
    v_sub_f32 v96, 0, v6
    v_sub_f32 v97, 0, v6
    v_sub_f32 v98, 0, v6
    v_sub_f32 v99, 0, v6
    v_sub_f32 v100, 0, v6
    v_sub_f32 v101, 0, v6
    v_sub_f32 v102, 0, v6
    v_sub_f32 v103, 0, v6
    v_sub_f32 v104, 0, v6
    v_sub_f32 v105, 0, v6
    v_sub_f32 v106, 0, v6
    v_sub_f32 v107, 0, v6
    v_sub_f32 v108, 0, v6
    v_sub_f32 v109, 0, v6
    v_sub_f32 v110, 0, v6
    v_sub_f32 v111, 0, v6
L_nomax_11:
    s_add_u32 m0, s47, 65536
    s_add_u32 s51, s45, 229376
    s_mov_b64 exec, s[48:49]
    buffer_load_dwordx4 v11, s[24:27], s51 offen sc1 lds
    s_mov_b64 exec, -1
    s_waitcnt lgkmcnt(4)
    v_mfma_f32_32x32x16_bf16 v[16:31], v[72:75], v[112:115], v[96:111]
    v_mfma_f32_32x32x16_bf16 v[16:31], v[76:79], v[116:119], v[16:31]
    s_waitcnt vmcnt(4)
    s_barrier
    s_nop 7
    s_setprio 2
    s_waitcnt lgkmcnt(2)
    v_mfma_f32_32x32x16_bf16 v[32:47], v[80:83], v[112:115], v[96:111]
    v_exp_f32 v16, v16
    v_exp_f32 v17, v17
    v_exp_f32 v18, v18
    v_exp_f32 v19, v19
    ds_read_b128 v[72:75], v13 offset:16384
    ds_read_b128 v[76:79], v13 offset:17408
    v_exp_f32 v20, v20
    v_exp_f32 v21, v21
    v_exp_f32 v22, v22
    v_exp_f32 v23, v23
    v_mfma_f32_32x32x16_bf16 v[32:47], v[84:87], v[116:119], v[32:47]
    s_add_u32 m0, s47, 73728
    s_add_u32 s51, s45, 258048
    s_mov_b64 exec, s[48:49]
    buffer_load_dwordx4 v11, s[24:27], s51 offen sc1 lds
    s_mov_b64 exec, -1
    v_cvt_pk_bf16_f32 v64, v16, v17
    v_cvt_pk_bf16_f32 v65, v18, v19
    v_cvt_pk_bf16_f32 v66, v20, v21
    v_cvt_pk_bf16_f32 v67, v22, v23
    ds_read_b128 v[120:123], v13 offset:10240
    ds_read_b128 v[124:127], v13 offset:11264
    v_exp_f32 v24, v24
    v_exp_f32 v25, v25
    v_exp_f32 v26, v26
    v_exp_f32 v27, v27
    s_waitcnt lgkmcnt(4)
    v_mfma_f32_32x32x16_bf16 v[48:63], v[88:91], v[64:67], 0
    s_add_u32 m0, s47, 81920
    s_add_u32 s51, s45, 286720
    s_mov_b64 exec, s[48:49]
    buffer_load_dwordx4 v11, s[24:27], s51 offen sc1 lds
    s_mov_b64 exec, -1
    v_exp_f32 v28, v28
    v_exp_f32 v29, v29
    v_exp_f32 v30, v30
    v_exp_f32 v31, v31
    v_cvt_pk_bf16_f32 v68, v24, v25
    v_cvt_pk_bf16_f32 v69, v26, v27
    v_cvt_pk_bf16_f32 v70, v28, v29
    v_cvt_pk_bf16_f32 v71, v30, v31
    s_setprio 1
    s_waitcnt lgkmcnt(2)
    v_mfma_f32_32x32x16_bf16 v[16:31], v[72:75], v[112:115], v[96:111]
    v_exp_f32 v32, v32
    v_exp_f32 v33, v33
    v_exp_f32 v34, v34
    v_exp_f32 v35, v35
    v_mfma_f32_32x32x16_bf16 v[48:63], v[92:95], v[68:71], v[48:63]
    ds_read_b128 v[80:83], v13 offset:24576
    ds_read_b128 v[84:87], v13 offset:25600
    v_exp_f32 v36, v36
    v_exp_f32 v37, v37
    v_exp_f32 v38, v38
    v_exp_f32 v39, v39
    v_mfma_f32_32x32x16_bf16 v[16:31], v[76:79], v[116:119], v[16:31]
    buffer_load_dword v5, v129, s[24:27], s56 offen sc1
    v_cvt_pk_bf16_f32 v64, v32, v33
    v_cvt_pk_bf16_f32 v65, v34, v35
    v_cvt_pk_bf16_f32 v66, v36, v37
    v_cvt_pk_bf16_f32 v67, v38, v39
    ds_read_b128 v[88:91], v13 offset:18432
    ds_read_b128 v[92:95], v13 offset:19456
    v_exp_f32 v40, v40
    v_exp_f32 v41, v41
    v_exp_f32 v42, v42
    v_exp_f32 v43, v43
    s_waitcnt lgkmcnt(4)
    v_mfma_f32_32x32x16_bf16 v[48:63], v[120:123], v[64:67], v[48:63]
    s_add_u32 m0, s47, 90112
    s_add_u32 s51, s45, 315392
    s_mov_b64 exec, s[48:49]
    buffer_load_dwordx4 v11, s[24:27], s51 offen sc1 lds
    s_mov_b64 exec, -1
    v_exp_f32 v44, v44
    v_exp_f32 v45, v45
    v_exp_f32 v46, v46
    v_exp_f32 v47, v47
    v_cvt_pk_bf16_f32 v68, v40, v41
    v_cvt_pk_bf16_f32 v69, v42, v43
    v_cvt_pk_bf16_f32 v70, v44, v45
    v_cvt_pk_bf16_f32 v71, v46, v47
    s_setprio 0
    s_waitcnt lgkmcnt(2)
    v_mfma_f32_32x32x16_bf16 v[32:47], v[80:83], v[112:115], v[96:111]
    v_exp_f32 v16, v16
    v_exp_f32 v17, v17
    v_exp_f32 v18, v18
    v_exp_f32 v19, v19
    v_mfma_f32_32x32x16_bf16 v[48:63], v[124:127], v[68:71], v[48:63]
    ds_read_b128 v[72:75], v13 offset:32768
    ds_read_b128 v[76:79], v13 offset:33792
    v_exp_f32 v20, v20
    v_exp_f32 v21, v21
    v_exp_f32 v22, v22
    v_exp_f32 v23, v23
    v_mfma_f32_32x32x16_bf16 v[32:47], v[84:87], v[116:119], v[32:47]
    s_add_u32 m0, s47, 98304
    s_add_u32 s51, s45, 344064
    s_mov_b64 exec, s[48:49]
    buffer_load_dwordx4 v11, s[24:27], s51 offen sc1 lds
    s_mov_b64 exec, -1
    v_cvt_pk_bf16_f32 v64, v16, v17
    v_cvt_pk_bf16_f32 v65, v18, v19
    v_cvt_pk_bf16_f32 v66, v20, v21
    v_cvt_pk_bf16_f32 v67, v22, v23
    ds_read_b128 v[120:123], v13 offset:26624
    ds_read_b128 v[124:127], v13 offset:27648
    v_exp_f32 v24, v24
    v_exp_f32 v25, v25
    v_exp_f32 v26, v26
    v_exp_f32 v27, v27
    s_waitcnt lgkmcnt(4)
    v_mfma_f32_32x32x16_bf16 v[48:63], v[88:91], v[64:67], v[48:63]
    s_add_u32 m0, s47, 106496
    s_add_u32 s51, s45, 372736
    s_mov_b64 exec, s[48:49]
    buffer_load_dwordx4 v11, s[24:27], s51 offen sc1 lds
    s_mov_b64 exec, -1
    v_exp_f32 v28, v28
    v_exp_f32 v29, v29
    v_exp_f32 v30, v30
    v_exp_f32 v31, v31
    v_cvt_pk_bf16_f32 v68, v24, v25
    v_cvt_pk_bf16_f32 v69, v26, v27
    v_cvt_pk_bf16_f32 v70, v28, v29
    v_cvt_pk_bf16_f32 v71, v30, v31
    s_waitcnt vmcnt(3)
    s_barrier
    v_cmp_gt_u32 vcc, 1, v5
    s_nop 0
    s_cbranch_vccnz L_tsl_12
L_tbk_13:
    s_setprio 3
    s_waitcnt lgkmcnt(2)
    v_mfma_f32_32x32x16_bf16 v[16:31], v[72:75], v[112:115], v[96:111]
    v_exp_f32 v32, v32
    v_exp_f32 v33, v33
    v_exp_f32 v34, v34
    v_exp_f32 v35, v35
    v_mfma_f32_32x32x16_bf16 v[48:63], v[92:95], v[68:71], v[48:63]
    ds_read_b128 v[80:83], v13 offset:40960
    ds_read_b128 v[84:87], v13 offset:41984
    s_add_u32 s52, s54, 0
    buffer_load_dwordx4 v[136:139], v3, s[24:27], s52 offen sc1
    v_exp_f32 v36, v36
    v_exp_f32 v37, v37
    v_exp_f32 v38, v38
    v_exp_f32 v39, v39
    v_mfma_f32_32x32x16_bf16 v[16:31], v[76:79], v[116:119], v[16:31]
    s_add_u32 m0, s47, 114688
    s_add_u32 s51, s45, 401408
    s_mov_b64 exec, s[48:49]
    buffer_load_dwordx4 v11, s[24:27], s51 offen sc1 lds
    s_mov_b64 exec, -1
    v_cvt_pk_bf16_f32 v64, v32, v33
    v_cvt_pk_bf16_f32 v65, v34, v35
    v_cvt_pk_bf16_f32 v66, v36, v37
    v_cvt_pk_bf16_f32 v67, v38, v39
    ds_read_b128 v[88:91], v13 offset:34816
    ds_read_b128 v[92:95], v13 offset:35840
    v_exp_f32 v40, v40
    v_exp_f32 v41, v41
    v_exp_f32 v42, v42
    v_exp_f32 v43, v43
    s_waitcnt lgkmcnt(4)
    v_mfma_f32_32x32x16_bf16 v[48:63], v[120:123], v[64:67], v[48:63]
    s_add_u32 m0, s47, 122880
    s_add_u32 s51, s45, 430080
    s_mov_b64 exec, s[48:49]
    buffer_load_dwordx4 v11, s[24:27], s51 offen sc1 lds
    s_mov_b64 exec, -1
    v_exp_f32 v44, v44
    v_exp_f32 v45, v45
    v_exp_f32 v46, v46
    v_exp_f32 v47, v47
    v_cvt_pk_bf16_f32 v68, v40, v41
    v_cvt_pk_bf16_f32 v69, v42, v43
    v_cvt_pk_bf16_f32 v70, v44, v45
    v_cvt_pk_bf16_f32 v71, v46, v47
    s_setprio 2
    s_waitcnt lgkmcnt(2)
    v_mfma_f32_32x32x16_bf16 v[32:47], v[80:83], v[112:115], v[96:111]
    v_exp_f32 v16, v16
    v_exp_f32 v17, v17
    v_exp_f32 v18, v18
    v_exp_f32 v19, v19
    v_mfma_f32_32x32x16_bf16 v[48:63], v[124:127], v[68:71], v[48:63]
    ds_read_b128 v[72:75], v13 offset:49152
    ds_read_b128 v[76:79], v13 offset:50176
    s_add_u32 s52, s54, 1024
    buffer_load_dwordx4 v[140:143], v3, s[24:27], s52 offen sc1
    v_exp_f32 v20, v20
    v_exp_f32 v21, v21
    v_exp_f32 v22, v22
    v_exp_f32 v23, v23
    v_mfma_f32_32x32x16_bf16 v[32:47], v[84:87], v[116:119], v[32:47]
    s_add_u32 m0, s47, 0
    s_add_u32 s51, s45, 458752
    s_mov_b64 exec, s[48:49]
    buffer_load_dwordx4 v11, s[24:27], s51 offen sc1 lds
    s_mov_b64 exec, -1
    v_cvt_pk_bf16_f32 v64, v16, v17
    v_cvt_pk_bf16_f32 v65, v18, v19
    v_cvt_pk_bf16_f32 v66, v20, v21
    v_cvt_pk_bf16_f32 v67, v22, v23
    ds_read_b128 v[120:123], v13 offset:43008
    ds_read_b128 v[124:127], v13 offset:44032
    v_exp_f32 v24, v24
    v_exp_f32 v25, v25
    v_exp_f32 v26, v26
    v_exp_f32 v27, v27
    s_waitcnt lgkmcnt(4)
    v_mfma_f32_32x32x16_bf16 v[48:63], v[88:91], v[64:67], v[48:63]
    s_add_u32 m0, s47, 8192
    s_add_u32 s51, s45, 487424
    s_mov_b64 exec, s[48:49]
    buffer_load_dwordx4 v11, s[24:27], s51 offen sc1 lds
    s_mov_b64 exec, -1
    v_exp_f32 v28, v28
    v_exp_f32 v29, v29
    v_exp_f32 v30, v30
    v_exp_f32 v31, v31
    v_cvt_pk_bf16_f32 v68, v24, v25
    v_cvt_pk_bf16_f32 v69, v26, v27
    v_cvt_pk_bf16_f32 v70, v28, v29
    v_cvt_pk_bf16_f32 v71, v30, v31
    s_setprio 1
    s_waitcnt lgkmcnt(2)
    v_mfma_f32_32x32x16_bf16 v[16:31], v[72:75], v[112:115], v[96:111]
    v_exp_f32 v32, v32
    v_exp_f32 v33, v33
    v_exp_f32 v34, v34
    v_exp_f32 v35, v35
    v_mfma_f32_32x32x16_bf16 v[48:63], v[92:95], v[68:71], v[48:63]
    ds_read_b128 v[80:83], v13 offset:57344
    ds_read_b128 v[84:87], v13 offset:58368
    s_add_u32 s52, s54, 2048
    buffer_load_dwordx4 v[144:147], v3, s[24:27], s52 offen sc1
    v_exp_f32 v36, v36
    v_exp_f32 v37, v37
    v_exp_f32 v38, v38
    v_exp_f32 v39, v39
    v_mfma_f32_32x32x16_bf16 v[16:31], v[76:79], v[116:119], v[16:31]
    s_add_u32 m0, s47, 16384
    s_add_u32 s51, s45, 516096
    s_mov_b64 exec, s[48:49]
    buffer_load_dwordx4 v11, s[24:27], s51 offen sc1 lds
    s_mov_b64 exec, -1
    v_cvt_pk_bf16_f32 v64, v32, v33
    v_cvt_pk_bf16_f32 v65, v34, v35
    v_cvt_pk_bf16_f32 v66, v36, v37
    v_cvt_pk_bf16_f32 v67, v38, v39
    ds_read_b128 v[88:91], v13 offset:51200
    ds_read_b128 v[92:95], v13 offset:52224
    v_exp_f32 v40, v40
    v_exp_f32 v41, v41
    v_exp_f32 v42, v42
    v_exp_f32 v43, v43
    s_waitcnt lgkmcnt(4)
    v_mfma_f32_32x32x16_bf16 v[48:63], v[120:123], v[64:67], v[48:63]
    buffer_load_dwordx4 v[132:135], v3, s[28:31], s57 offen
    v_exp_f32 v44, v44
    v_exp_f32 v45, v45
    v_exp_f32 v46, v46
    v_exp_f32 v47, v47
    v_cvt_pk_bf16_f32 v68, v40, v41
    v_cvt_pk_bf16_f32 v69, v42, v43
    v_cvt_pk_bf16_f32 v70, v44, v45
    v_cvt_pk_bf16_f32 v71, v46, v47
    s_setprio 0
    s_waitcnt lgkmcnt(2)
    v_mfma_f32_32x32x16_bf16 v[32:47], v[80:83], v[112:115], v[96:111]
    v_exp_f32 v16, v16
    v_exp_f32 v17, v17
    v_exp_f32 v18, v18
    v_exp_f32 v19, v19
    v_mfma_f32_32x32x16_bf16 v[48:63], v[124:127], v[68:71], v[48:63]
    ds_read_b128 v[72:75], v14 offset:0
    ds_read_b128 v[76:79], v14 offset:1024
    s_add_u32 s52, s54, 3072
    buffer_load_dwordx4 v[148:151], v3, s[24:27], s52 offen sc1
    v_exp_f32 v20, v20
    v_exp_f32 v21, v21
    v_exp_f32 v22, v22
    v_exp_f32 v23, v23
    v_mfma_f32_32x32x16_bf16 v[32:47], v[84:87], v[116:119], v[32:47]
    s_mov_b32 s32, s16
    s_mov_b32 s33, s17
    s_mov_b32 s34, 1605632
    s_mov_b32 s35, 0x20000
    buffer_load_dwordx4 v[132:135], v3, s[32:35], s57 offen
    v_cvt_pk_bf16_f32 v64, v16, v17
    v_cvt_pk_bf16_f32 v65, v18, v19
    v_cvt_pk_bf16_f32 v66, v20, v21
    v_cvt_pk_bf16_f32 v67, v22, v23
    ds_read_b128 v[120:123], v13 offset:59392
    ds_read_b128 v[124:127], v13 offset:60416
    v_exp_f32 v24, v24
    v_exp_f32 v25, v25
    v_exp_f32 v26, v26
    v_exp_f32 v27, v27
    s_waitcnt lgkmcnt(4)
    v_mfma_f32_32x32x16_bf16 v[48:63], v[88:91], v[64:67], v[48:63]
    v_exp_f32 v28, v28
    v_exp_f32 v29, v29
    v_exp_f32 v30, v30
    v_exp_f32 v31, v31
    v_cvt_pk_bf16_f32 v68, v24, v25
    v_cvt_pk_bf16_f32 v69, v26, v27
    v_cvt_pk_bf16_f32 v70, v28, v29
    v_cvt_pk_bf16_f32 v71, v30, v31
    s_waitcnt vmcnt(8)
    s_barrier
    s_setprio 3
    s_waitcnt lgkmcnt(2)
    v_mfma_f32_32x32x16_bf16 v[16:31], v[72:75], v[112:115], v[96:111]
    v_exp_f32 v32, v32
    v_exp_f32 v33, v33
    v_exp_f32 v34, v34
    v_exp_f32 v35, v35
    v_mfma_f32_32x32x16_bf16 v[48:63], v[92:95], v[68:71], v[48:63]
    ds_read_b128 v[80:83], v14 offset:8192
    ds_read_b128 v[84:87], v14 offset:9216
    s_add_u32 s52, s54, 4096
    buffer_load_dwordx4 v[152:155], v3, s[24:27], s52 offen sc1
    v_exp_f32 v36, v36
    v_exp_f32 v37, v37
    v_exp_f32 v38, v38
    v_exp_f32 v39, v39
    v_mfma_f32_32x32x16_bf16 v[16:31], v[76:79], v[116:119], v[16:31]
    s_add_u32 m0, s47, 24576
    s_add_u32 s51, s45, 544768
    s_mov_b64 exec, s[48:49]
    buffer_load_dwordx4 v11, s[24:27], s51 offen sc1 lds
    s_mov_b64 exec, -1
    v_cvt_pk_bf16_f32 v64, v32, v33
    v_cvt_pk_bf16_f32 v65, v34, v35
    v_cvt_pk_bf16_f32 v66, v36, v37
    v_cvt_pk_bf16_f32 v67, v38, v39
    ds_read_b128 v[88:91], v14 offset:2048
    ds_read_b128 v[92:95], v14 offset:3072
    v_exp_f32 v40, v40
    v_exp_f32 v41, v41
    v_exp_f32 v42, v42
    v_exp_f32 v43, v43
    s_waitcnt lgkmcnt(4)
    v_mfma_f32_32x32x16_bf16 v[48:63], v[120:123], v[64:67], v[48:63]
    s_add_u32 m0, s47, 32768
    s_add_u32 s51, s45, 573440
    s_mov_b64 exec, s[48:49]
    buffer_load_dwordx4 v11, s[24:27], s51 offen sc1 lds
    s_mov_b64 exec, -1
    v_exp_f32 v44, v44
    v_exp_f32 v45, v45
    v_exp_f32 v46, v46
    v_exp_f32 v47, v47
    v_cvt_pk_bf16_f32 v68, v40, v41
    v_cvt_pk_bf16_f32 v69, v42, v43
    v_cvt_pk_bf16_f32 v70, v44, v45
    v_cvt_pk_bf16_f32 v71, v46, v47
    s_waitcnt lgkmcnt(2)
    v_mfma_f32_32x32x16_bf16 v[32:47], v[80:83], v[112:115], v[96:111]
    v_exp_f32 v16, v16
    v_exp_f32 v17, v17
    v_exp_f32 v18, v18
    v_exp_f32 v19, v19
    v_mfma_f32_32x32x16_bf16 v[48:63], v[124:127], v[68:71], v[48:63]
    ds_read_b128 v[72:75], v14 offset:16384
    ds_read_b128 v[76:79], v14 offset:17408
    s_add_u32 s52, s54, 5120
    buffer_load_dwordx4 v[156:159], v3, s[24:27], s52 offen sc1
    v_exp_f32 v20, v20
    v_exp_f32 v21, v21
    v_exp_f32 v22, v22
    v_exp_f32 v23, v23
    v_mfma_f32_32x32x16_bf16 v[32:47], v[84:87], v[116:119], v[32:47]
    s_add_u32 m0, s47, 40960
    s_add_u32 s51, s45, 602112
    s_mov_b64 exec, s[48:49]
    buffer_load_dwordx4 v11, s[24:27], s51 offen sc1 lds
    s_mov_b64 exec, -1
    v_cvt_pk_bf16_f32 v64, v16, v17
    v_cvt_pk_bf16_f32 v65, v18, v19
    v_cvt_pk_bf16_f32 v66, v20, v21
    v_cvt_pk_bf16_f32 v67, v22, v23
    ds_read_b128 v[120:123], v14 offset:10240
    ds_read_b128 v[124:127], v14 offset:11264
    v_exp_f32 v24, v24
    v_exp_f32 v25, v25
    v_exp_f32 v26, v26
    v_exp_f32 v27, v27
    s_waitcnt lgkmcnt(4)
    v_mfma_f32_32x32x16_bf16 v[48:63], v[88:91], v[64:67], v[48:63]
    s_add_u32 m0, s47, 49152
    s_add_u32 s51, s45, 630784
    s_mov_b64 exec, s[48:49]
    buffer_load_dwordx4 v11, s[24:27], s51 offen sc1 lds
    s_mov_b64 exec, -1
    v_exp_f32 v28, v28
    v_exp_f32 v29, v29
    v_exp_f32 v30, v30
    v_exp_f32 v31, v31
    v_cvt_pk_bf16_f32 v68, v24, v25
    v_cvt_pk_bf16_f32 v69, v26, v27
    v_cvt_pk_bf16_f32 v70, v28, v29
    v_cvt_pk_bf16_f32 v71, v30, v31
    s_waitcnt lgkmcnt(2)
    v_mfma_f32_32x32x16_bf16 v[16:31], v[72:75], v[112:115], v[96:111]
    v_exp_f32 v32, v32
    v_exp_f32 v33, v33
    v_exp_f32 v34, v34
    v_exp_f32 v35, v35
    v_mfma_f32_32x32x16_bf16 v[48:63], v[92:95], v[68:71], v[48:63]
    ds_read_b128 v[80:83], v14 offset:24576
    ds_read_b128 v[84:87], v14 offset:25600
    s_add_u32 s52, s54, 6144
    buffer_load_dwordx4 v[160:163], v3, s[24:27], s52 offen sc1
    v_exp_f32 v36, v36
    v_exp_f32 v37, v37
    v_exp_f32 v38, v38
    v_exp_f32 v39, v39
    v_mfma_f32_32x32x16_bf16 v[16:31], v[76:79], v[116:119], v[16:31]
    v_cvt_pk_bf16_f32 v64, v32, v33
    v_cvt_pk_bf16_f32 v65, v34, v35
    v_cvt_pk_bf16_f32 v66, v36, v37
    v_cvt_pk_bf16_f32 v67, v38, v39
    ds_read_b128 v[88:91], v14 offset:18432
    ds_read_b128 v[92:95], v14 offset:19456
    v_exp_f32 v40, v40
    v_exp_f32 v41, v41
    v_exp_f32 v42, v42
    v_exp_f32 v43, v43
    s_waitcnt lgkmcnt(4)
    v_mfma_f32_32x32x16_bf16 v[48:63], v[120:123], v[64:67], v[48:63]
    v_exp_f32 v44, v44
    v_exp_f32 v45, v45
    v_exp_f32 v46, v46
    v_exp_f32 v47, v47
    v_cvt_pk_bf16_f32 v68, v40, v41
    v_cvt_pk_bf16_f32 v69, v42, v43
    v_cvt_pk_bf16_f32 v70, v44, v45
    v_cvt_pk_bf16_f32 v71, v46, v47
    s_setprio 2
    s_waitcnt lgkmcnt(2)
    v_mfma_f32_32x32x16_bf16 v[32:47], v[80:83], v[112:115], v[96:111]
    v_exp_f32 v16, v16
    v_exp_f32 v17, v17
    v_exp_f32 v18, v18
    v_exp_f32 v19, v19
    v_mfma_f32_32x32x16_bf16 v[48:63], v[124:127], v[68:71], v[48:63]
    ds_read_b128 v[72:75], v14 offset:32768
    ds_read_b128 v[76:79], v14 offset:33792
    s_add_u32 s52, s54, 28672
    buffer_load_dwordx4 v[164:167], v3, s[24:27], s52 offen sc1
    v_exp_f32 v20, v20
    v_exp_f32 v21, v21
    v_exp_f32 v22, v22
    v_exp_f32 v23, v23
    v_mfma_f32_32x32x16_bf16 v[32:47], v[84:87], v[116:119], v[32:47]
    v_cvt_pk_bf16_f32 v64, v16, v17
    v_cvt_pk_bf16_f32 v65, v18, v19
    v_cvt_pk_bf16_f32 v66, v20, v21
    v_cvt_pk_bf16_f32 v67, v22, v23
    ds_read_b128 v[120:123], v14 offset:26624
    ds_read_b128 v[124:127], v14 offset:27648
    v_exp_f32 v24, v24
    v_exp_f32 v25, v25
    v_exp_f32 v26, v26
    v_exp_f32 v27, v27
    s_waitcnt lgkmcnt(4)
    v_mfma_f32_32x32x16_bf16 v[48:63], v[88:91], v[64:67], v[48:63]
    v_exp_f32 v28, v28
    v_exp_f32 v29, v29
    v_exp_f32 v30, v30
    v_exp_f32 v31, v31
    v_cvt_pk_bf16_f32 v68, v24, v25
    v_cvt_pk_bf16_f32 v69, v26, v27
    v_cvt_pk_bf16_f32 v70, v28, v29
    v_cvt_pk_bf16_f32 v71, v30, v31
    s_waitcnt lgkmcnt(2)
    v_mfma_f32_32x32x16_bf16 v[16:31], v[72:75], v[112:115], v[96:111]
    v_exp_f32 v32, v32
    v_exp_f32 v33, v33
    v_exp_f32 v34, v34
    v_exp_f32 v35, v35
    v_mfma_f32_32x32x16_bf16 v[48:63], v[92:95], v[68:71], v[48:63]
    ds_read_b128 v[80:83], v14 offset:40960
    ds_read_b128 v[84:87], v14 offset:41984
    s_add_u32 s52, s54, 29696
    buffer_load_dwordx4 v[168:171], v3, s[24:27], s52 offen sc1
    v_exp_f32 v36, v36
    v_exp_f32 v37, v37
    v_exp_f32 v38, v38
    v_exp_f32 v39, v39
    v_mfma_f32_32x32x16_bf16 v[16:31], v[76:79], v[116:119], v[16:31]
    v_cvt_pk_bf16_f32 v64, v32, v33
    v_cvt_pk_bf16_f32 v65, v34, v35
    v_cvt_pk_bf16_f32 v66, v36, v37
    v_cvt_pk_bf16_f32 v67, v38, v39
    ds_read_b128 v[88:91], v14 offset:34816
    ds_read_b128 v[92:95], v14 offset:35840
    v_exp_f32 v40, v40
    v_exp_f32 v41, v41
    v_exp_f32 v42, v42
    v_exp_f32 v43, v43
    s_waitcnt lgkmcnt(4)
    v_mfma_f32_32x32x16_bf16 v[48:63], v[120:123], v[64:67], v[48:63]
    v_exp_f32 v44, v44
    v_exp_f32 v45, v45
    v_exp_f32 v46, v46
    v_exp_f32 v47, v47
    v_cvt_pk_bf16_f32 v68, v40, v41
    v_cvt_pk_bf16_f32 v69, v42, v43
    v_cvt_pk_bf16_f32 v70, v44, v45
    v_cvt_pk_bf16_f32 v71, v46, v47
    s_setprio 1
    s_waitcnt lgkmcnt(2)
    v_mfma_f32_32x32x16_bf16 v[32:47], v[80:83], v[112:115], v[96:111]
    v_exp_f32 v16, v16
    v_exp_f32 v17, v17
    v_exp_f32 v18, v18
    v_exp_f32 v19, v19
    v_mfma_f32_32x32x16_bf16 v[48:63], v[124:127], v[68:71], v[48:63]
    ds_read_b128 v[72:75], v14 offset:49152
    ds_read_b128 v[76:79], v14 offset:50176
    s_add_u32 s52, s54, 30720
    buffer_load_dwordx4 v[172:175], v3, s[24:27], s52 offen sc1
    v_exp_f32 v20, v20
    v_exp_f32 v21, v21
    v_exp_f32 v22, v22
    v_exp_f32 v23, v23
    v_mfma_f32_32x32x16_bf16 v[32:47], v[84:87], v[116:119], v[32:47]
    v_cvt_pk_bf16_f32 v64, v16, v17
    v_cvt_pk_bf16_f32 v65, v18, v19
    v_cvt_pk_bf16_f32 v66, v20, v21
    v_cvt_pk_bf16_f32 v67, v22, v23
    ds_read_b128 v[120:123], v14 offset:43008
    ds_read_b128 v[124:127], v14 offset:44032
    v_exp_f32 v24, v24
    v_exp_f32 v25, v25
    v_exp_f32 v26, v26
    v_exp_f32 v27, v27
    s_waitcnt lgkmcnt(4)
    v_mfma_f32_32x32x16_bf16 v[48:63], v[88:91], v[64:67], v[48:63]
    v_exp_f32 v28, v28
    v_exp_f32 v29, v29
    v_exp_f32 v30, v30
    v_exp_f32 v31, v31
    v_cvt_pk_bf16_f32 v68, v24, v25
    v_cvt_pk_bf16_f32 v69, v26, v27
    v_cvt_pk_bf16_f32 v70, v28, v29
    v_cvt_pk_bf16_f32 v71, v30, v31
    s_setprio 0
    s_waitcnt lgkmcnt(2)
    v_mfma_f32_32x32x16_bf16 v[16:31], v[72:75], v[112:115], v[96:111]
    v_exp_f32 v32, v32
    v_exp_f32 v33, v33
    v_exp_f32 v34, v34
    v_exp_f32 v35, v35
    v_mfma_f32_32x32x16_bf16 v[48:63], v[92:95], v[68:71], v[48:63]
    ds_read_b128 v[80:83], v14 offset:57344
    ds_read_b128 v[84:87], v14 offset:58368
    s_add_u32 s52, s54, 31744
    buffer_load_dwordx4 v[176:179], v3, s[24:27], s52 offen sc1
    v_exp_f32 v36, v36
    v_exp_f32 v37, v37
    v_exp_f32 v38, v38
    v_exp_f32 v39, v39
    v_mfma_f32_32x32x16_bf16 v[16:31], v[76:79], v[116:119], v[16:31]
    v_cvt_pk_bf16_f32 v64, v32, v33
    v_cvt_pk_bf16_f32 v65, v34, v35
    v_cvt_pk_bf16_f32 v66, v36, v37
    v_cvt_pk_bf16_f32 v67, v38, v39
    ds_read_b128 v[88:91], v14 offset:51200
    ds_read_b128 v[92:95], v14 offset:52224
    v_exp_f32 v40, v40
    v_exp_f32 v41, v41
    v_exp_f32 v42, v42
    v_exp_f32 v43, v43
    s_waitcnt lgkmcnt(4)
    v_mfma_f32_32x32x16_bf16 v[48:63], v[120:123], v[64:67], v[48:63]
    v_exp_f32 v44, v44
    v_exp_f32 v45, v45
    v_exp_f32 v46, v46
    v_exp_f32 v47, v47
    v_cvt_pk_bf16_f32 v68, v40, v41
    v_cvt_pk_bf16_f32 v69, v42, v43
    v_cvt_pk_bf16_f32 v70, v44, v45
    v_cvt_pk_bf16_f32 v71, v46, v47
    s_waitcnt vmcnt(5)
    s_barrier
    s_setprio 3
    s_waitcnt lgkmcnt(2)
    v_mfma_f32_32x32x16_bf16 v[32:47], v[80:83], v[112:115], v[96:111]
    v_exp_f32 v16, v16
    v_exp_f32 v17, v17
    v_exp_f32 v18, v18
    v_exp_f32 v19, v19
    v_mfma_f32_32x32x16_bf16 v[48:63], v[124:127], v[68:71], v[48:63]
    ds_read_b128 v[72:75], v13 offset:0
    ds_read_b128 v[76:79], v13 offset:1024
    s_add_u32 s52, s54, 32768
    buffer_load_dwordx4 v[180:183], v3, s[24:27], s52 offen sc1
    v_exp_f32 v20, v20
    v_exp_f32 v21, v21
    v_exp_f32 v22, v22
    v_exp_f32 v23, v23
    v_mfma_f32_32x32x16_bf16 v[32:47], v[84:87], v[116:119], v[32:47]
    s_add_u32 m0, s47, 57344
    s_add_u32 s51, s45, 659456
    s_mov_b64 exec, s[48:49]
    buffer_load_dwordx4 v11, s[24:27], s51 offen sc1 lds
    s_mov_b64 exec, -1
    v_cvt_pk_bf16_f32 v64, v16, v17
    v_cvt_pk_bf16_f32 v65, v18, v19
    v_cvt_pk_bf16_f32 v66, v20, v21
    v_cvt_pk_bf16_f32 v67, v22, v23
    ds_read_b128 v[120:123], v14 offset:59392
    ds_read_b128 v[124:127], v14 offset:60416
    v_exp_f32 v24, v24
    v_exp_f32 v25, v25
    v_exp_f32 v26, v26
    v_exp_f32 v27, v27
    s_waitcnt lgkmcnt(4)
    v_mfma_f32_32x32x16_bf16 v[48:63], v[88:91], v[64:67], v[48:63]
    s_add_u32 m0, s47, 65536
    s_add_u32 s51, s45, 688128
    s_mov_b64 exec, s[48:49]
    buffer_load_dwordx4 v11, s[24:27], s51 offen sc1 lds
    s_mov_b64 exec, -1
    v_exp_f32 v28, v28
    v_exp_f32 v29, v29
    v_exp_f32 v30, v30
    v_exp_f32 v31, v31
    v_cvt_pk_bf16_f32 v68, v24, v25
    v_cvt_pk_bf16_f32 v69, v26, v27
    v_cvt_pk_bf16_f32 v70, v28, v29
    v_cvt_pk_bf16_f32 v71, v30, v31
    s_waitcnt lgkmcnt(2)
    v_mfma_f32_32x32x16_bf16 v[16:31], v[72:75], v[112:115], v[96:111]
    v_exp_f32 v32, v32
    v_exp_f32 v33, v33
    v_exp_f32 v34, v34
    v_exp_f32 v35, v35
    v_mfma_f32_32x32x16_bf16 v[48:63], v[92:95], v[68:71], v[48:63]
    ds_read_b128 v[80:83], v13 offset:8192
    ds_read_b128 v[84:87], v13 offset:9216
    s_add_u32 s52, s54, 33792
    buffer_load_dwordx4 v[184:187], v3, s[24:27], s52 offen sc1
    v_exp_f32 v36, v36
    v_exp_f32 v37, v37
    v_exp_f32 v38, v38
    v_exp_f32 v39, v39
    v_mfma_f32_32x32x16_bf16 v[16:31], v[76:79], v[116:119], v[16:31]
    s_add_u32 m0, s47, 73728
    s_add_u32 s51, s45, 716800
    s_mov_b64 exec, s[48:49]
    buffer_load_dwordx4 v11, s[24:27], s51 offen sc1 lds
    s_mov_b64 exec, -1
    v_cvt_pk_bf16_f32 v64, v32, v33
    v_cvt_pk_bf16_f32 v65, v34, v35
    v_cvt_pk_bf16_f32 v66, v36, v37
    v_cvt_pk_bf16_f32 v67, v38, v39
    ds_read_b128 v[88:91], v13 offset:2048
    ds_read_b128 v[92:95], v13 offset:3072
    v_exp_f32 v40, v40
    v_exp_f32 v41, v41
    v_exp_f32 v42, v42
    v_exp_f32 v43, v43
    s_waitcnt lgkmcnt(4)
    v_mfma_f32_32x32x16_bf16 v[48:63], v[120:123], v[64:67], v[48:63]
    s_add_u32 m0, s47, 81920
    s_add_u32 s51, s45, 745472
    s_mov_b64 exec, s[48:49]
    buffer_load_dwordx4 v11, s[24:27], s51 offen sc1 lds
    s_mov_b64 exec, -1
    v_exp_f32 v44, v44
    v_exp_f32 v45, v45
    v_exp_f32 v46, v46
    v_exp_f32 v47, v47
    v_cvt_pk_bf16_f32 v68, v40, v41
    v_cvt_pk_bf16_f32 v69, v42, v43
    v_cvt_pk_bf16_f32 v70, v44, v45
    v_cvt_pk_bf16_f32 v71, v46, v47
    s_waitcnt lgkmcnt(2)
    v_mfma_f32_32x32x16_bf16 v[32:47], v[80:83], v[112:115], v[96:111]
    v_exp_f32 v16, v16
    v_exp_f32 v17, v17
    v_exp_f32 v18, v18
    v_exp_f32 v19, v19
    v_mfma_f32_32x32x16_bf16 v[48:63], v[124:127], v[68:71], v[48:63]
    ds_read_b128 v[72:75], v13 offset:16384
    ds_read_b128 v[76:79], v13 offset:17408
    s_add_u32 s52, s54, 34816
    buffer_load_dwordx4 v[188:191], v3, s[24:27], s52 offen sc1
    v_exp_f32 v20, v20
    v_exp_f32 v21, v21
    v_exp_f32 v22, v22
    v_exp_f32 v23, v23
    v_mfma_f32_32x32x16_bf16 v[32:47], v[84:87], v[116:119], v[32:47]
    s_add_u32 m0, s47, 90112
    s_add_u32 s51, s45, 774144
    s_mov_b64 exec, s[48:49]
    buffer_load_dwordx4 v11, s[24:27], s51 offen sc1 lds
    s_mov_b64 exec, -1
    v_cvt_pk_bf16_f32 v64, v16, v17
    v_cvt_pk_bf16_f32 v65, v18, v19
    v_cvt_pk_bf16_f32 v66, v20, v21
    v_cvt_pk_bf16_f32 v67, v22, v23
    ds_read_b128 v[120:123], v13 offset:10240
    ds_read_b128 v[124:127], v13 offset:11264
    v_exp_f32 v24, v24
    v_exp_f32 v25, v25
    v_exp_f32 v26, v26
    v_exp_f32 v27, v27
    s_waitcnt lgkmcnt(4)
    v_mfma_f32_32x32x16_bf16 v[48:63], v[88:91], v[64:67], v[48:63]
    s_add_u32 m0, s47, 98304
    s_add_u32 s51, s45, 802816
    s_mov_b64 exec, s[48:49]
    buffer_load_dwordx4 v11, s[24:27], s51 offen sc1 lds
    s_mov_b64 exec, -1
    v_exp_f32 v28, v28
    v_exp_f32 v29, v29
    v_exp_f32 v30, v30
    v_exp_f32 v31, v31
    v_cvt_pk_bf16_f32 v68, v24, v25
    v_cvt_pk_bf16_f32 v69, v26, v27
    v_cvt_pk_bf16_f32 v70, v28, v29
    v_cvt_pk_bf16_f32 v71, v30, v31
    s_setprio 2
    s_waitcnt lgkmcnt(2)
    v_mfma_f32_32x32x16_bf16 v[16:31], v[72:75], v[112:115], v[96:111]
    v_exp_f32 v32, v32
    v_exp_f32 v33, v33
    v_exp_f32 v34, v34
    v_exp_f32 v35, v35
    v_mfma_f32_32x32x16_bf16 v[48:63], v[92:95], v[68:71], v[48:63]
    ds_read_b128 v[80:83], v13 offset:24576
    ds_read_b128 v[84:87], v13 offset:25600
    s_add_u32 s52, s54, 57344
    buffer_load_dwordx4 v[192:195], v3, s[24:27], s52 offen sc1
    v_exp_f32 v36, v36
    v_exp_f32 v37, v37
    v_exp_f32 v38, v38
    v_exp_f32 v39, v39
    v_mfma_f32_32x32x16_bf16 v[16:31], v[76:79], v[116:119], v[16:31]
    s_add_u32 m0, s47, 106496
    s_add_u32 s51, s45, 831488
    s_mov_b64 exec, s[48:49]
    buffer_load_dwordx4 v11, s[24:27], s51 offen sc1 lds
    s_mov_b64 exec, -1
    v_cvt_pk_bf16_f32 v64, v32, v33
    v_cvt_pk_bf16_f32 v65, v34, v35
    v_cvt_pk_bf16_f32 v66, v36, v37
    v_cvt_pk_bf16_f32 v67, v38, v39
    ds_read_b128 v[88:91], v13 offset:18432
    ds_read_b128 v[92:95], v13 offset:19456
    v_exp_f32 v40, v40
    v_exp_f32 v41, v41
    v_exp_f32 v42, v42
    v_exp_f32 v43, v43
    s_waitcnt lgkmcnt(4)
    v_mfma_f32_32x32x16_bf16 v[48:63], v[120:123], v[64:67], v[48:63]
    v_exp_f32 v44, v44
    v_exp_f32 v45, v45
    v_exp_f32 v46, v46
    v_exp_f32 v47, v47
    v_cvt_pk_bf16_f32 v68, v40, v41
    v_cvt_pk_bf16_f32 v69, v42, v43
    v_cvt_pk_bf16_f32 v70, v44, v45
    v_cvt_pk_bf16_f32 v71, v46, v47
    s_waitcnt lgkmcnt(2)
    v_mfma_f32_32x32x16_bf16 v[32:47], v[80:83], v[112:115], v[96:111]
    v_exp_f32 v16, v16
    v_exp_f32 v17, v17
    v_exp_f32 v18, v18
    v_exp_f32 v19, v19
    v_mfma_f32_32x32x16_bf16 v[48:63], v[124:127], v[68:71], v[48:63]
    ds_read_b128 v[72:75], v13 offset:32768
    ds_read_b128 v[76:79], v13 offset:33792
    s_add_u32 s52, s54, 58368
    buffer_load_dwordx4 v[196:199], v3, s[24:27], s52 offen sc1
    v_exp_f32 v20, v20
    v_exp_f32 v21, v21
    v_exp_f32 v22, v22
    v_exp_f32 v23, v23
    v_mfma_f32_32x32x16_bf16 v[32:47], v[84:87], v[116:119], v[32:47]
    v_cvt_pk_bf16_f32 v64, v16, v17
    v_cvt_pk_bf16_f32 v65, v18, v19
    v_cvt_pk_bf16_f32 v66, v20, v21
    v_cvt_pk_bf16_f32 v67, v22, v23
    ds_read_b128 v[120:123], v13 offset:26624
    ds_read_b128 v[124:127], v13 offset:27648
    v_exp_f32 v24, v24
    v_exp_f32 v25, v25
    v_exp_f32 v26, v26
    v_exp_f32 v27, v27
    s_waitcnt lgkmcnt(4)
    v_mfma_f32_32x32x16_bf16 v[48:63], v[88:91], v[64:67], v[48:63]
    v_exp_f32 v28, v28
    v_exp_f32 v29, v29
    v_exp_f32 v30, v30
    v_exp_f32 v31, v31
    v_cvt_pk_bf16_f32 v68, v24, v25
    v_cvt_pk_bf16_f32 v69, v26, v27
    v_cvt_pk_bf16_f32 v70, v28, v29
    v_cvt_pk_bf16_f32 v71, v30, v31
    s_setprio 1
    s_waitcnt lgkmcnt(2)
    v_mfma_f32_32x32x16_bf16 v[16:31], v[72:75], v[112:115], v[96:111]
    v_exp_f32 v32, v32
    v_exp_f32 v33, v33
    v_exp_f32 v34, v34
    v_exp_f32 v35, v35
    v_mfma_f32_32x32x16_bf16 v[48:63], v[92:95], v[68:71], v[48:63]
    ds_read_b128 v[80:83], v13 offset:40960
    ds_read_b128 v[84:87], v13 offset:41984
    s_add_u32 s52, s54, 59392
    buffer_load_dwordx4 v[200:203], v3, s[24:27], s52 offen sc1
    v_exp_f32 v36, v36
    v_exp_f32 v37, v37
    v_exp_f32 v38, v38
    v_exp_f32 v39, v39
    v_mfma_f32_32x32x16_bf16 v[16:31], v[76:79], v[116:119], v[16:31]
    v_cvt_pk_bf16_f32 v64, v32, v33
    v_cvt_pk_bf16_f32 v65, v34, v35
    v_cvt_pk_bf16_f32 v66, v36, v37
    v_cvt_pk_bf16_f32 v67, v38, v39
    ds_read_b128 v[88:91], v13 offset:34816
    ds_read_b128 v[92:95], v13 offset:35840
    v_exp_f32 v40, v40
    v_exp_f32 v41, v41
    v_exp_f32 v42, v42
    v_exp_f32 v43, v43
    s_waitcnt lgkmcnt(4)
    v_mfma_f32_32x32x16_bf16 v[48:63], v[120:123], v[64:67], v[48:63]
    v_exp_f32 v44, v44
    v_exp_f32 v45, v45
    v_exp_f32 v46, v46
    v_exp_f32 v47, v47
    v_cvt_pk_bf16_f32 v68, v40, v41
    v_cvt_pk_bf16_f32 v69, v42, v43
    v_cvt_pk_bf16_f32 v70, v44, v45
    v_cvt_pk_bf16_f32 v71, v46, v47
    s_setprio 0
    s_waitcnt lgkmcnt(2)
    v_mfma_f32_32x32x16_bf16 v[32:47], v[80:83], v[112:115], v[96:111]
    v_exp_f32 v16, v16
    v_exp_f32 v17, v17
    v_exp_f32 v18, v18
    v_exp_f32 v19, v19
    v_mfma_f32_32x32x16_bf16 v[48:63], v[124:127], v[68:71], v[48:63]
    ds_read_b128 v[72:75], v13 offset:49152
    ds_read_b128 v[76:79], v13 offset:50176
    s_add_u32 s52, s54, 60416
    buffer_load_dwordx4 v[204:207], v3, s[24:27], s52 offen sc1
    v_exp_f32 v20, v20
    v_exp_f32 v21, v21
    v_exp_f32 v22, v22
    v_exp_f32 v23, v23
    v_mfma_f32_32x32x16_bf16 v[32:47], v[84:87], v[116:119], v[32:47]
    v_cvt_pk_bf16_f32 v64, v16, v17
    v_cvt_pk_bf16_f32 v65, v18, v19
    v_cvt_pk_bf16_f32 v66, v20, v21
    v_cvt_pk_bf16_f32 v67, v22, v23
    ds_read_b128 v[120:123], v13 offset:43008
    ds_read_b128 v[124:127], v13 offset:44032
    v_exp_f32 v24, v24
    v_exp_f32 v25, v25
    v_exp_f32 v26, v26
    v_exp_f32 v27, v27
    s_waitcnt lgkmcnt(4)
    v_mfma_f32_32x32x16_bf16 v[48:63], v[88:91], v[64:67], v[48:63]
    v_exp_f32 v28, v28
    v_exp_f32 v29, v29
    v_exp_f32 v30, v30
    v_exp_f32 v31, v31
    v_cvt_pk_bf16_f32 v68, v24, v25
    v_cvt_pk_bf16_f32 v69, v26, v27
    v_cvt_pk_bf16_f32 v70, v28, v29
    v_cvt_pk_bf16_f32 v71, v30, v31
    s_waitcnt vmcnt(3)
    s_barrier
    s_setprio 3
    s_waitcnt lgkmcnt(2)
    v_mfma_f32_32x32x16_bf16 v[16:31], v[72:75], v[112:115], v[96:111]
    v_exp_f32 v32, v32
    v_exp_f32 v33, v33
    v_exp_f32 v34, v34
    v_exp_f32 v35, v35
    v_mfma_f32_32x32x16_bf16 v[48:63], v[92:95], v[68:71], v[48:63]
    ds_read_b128 v[80:83], v13 offset:57344
    ds_read_b128 v[84:87], v13 offset:58368
    s_add_u32 s52, s54, 61440
    buffer_load_dwordx4 v[208:211], v3, s[24:27], s52 offen sc1
    v_exp_f32 v36, v36
    v_exp_f32 v37, v37
    v_exp_f32 v38, v38
    v_exp_f32 v39, v39
    v_mfma_f32_32x32x16_bf16 v[16:31], v[76:79], v[116:119], v[16:31]
    s_add_u32 m0, s47, 114688
    s_add_u32 s51, s45, 860160
    s_mov_b64 exec, s[48:49]
    buffer_load_dwordx4 v11, s[24:27], s51 offen sc1 lds
    s_mov_b64 exec, -1
    v_cvt_pk_bf16_f32 v64, v32, v33
    v_cvt_pk_bf16_f32 v65, v34, v35
    v_cvt_pk_bf16_f32 v66, v36, v37
    v_cvt_pk_bf16_f32 v67, v38, v39
    ds_read_b128 v[88:91], v13 offset:51200
    ds_read_b128 v[92:95], v13 offset:52224
    v_exp_f32 v40, v40
    v_exp_f32 v41, v41
    v_exp_f32 v42, v42
    v_exp_f32 v43, v43
    s_waitcnt lgkmcnt(4)
    v_mfma_f32_32x32x16_bf16 v[48:63], v[120:123], v[64:67], v[48:63]
    s_add_u32 m0, s47, 122880
    s_add_u32 s51, s45, 888832
    s_mov_b64 exec, s[48:49]
    buffer_load_dwordx4 v11, s[24:27], s51 offen sc1 lds
    s_mov_b64 exec, -1
    v_exp_f32 v44, v44
    v_exp_f32 v45, v45
    v_exp_f32 v46, v46
    v_exp_f32 v47, v47
    v_cvt_pk_bf16_f32 v68, v40, v41
    v_cvt_pk_bf16_f32 v69, v42, v43
    v_cvt_pk_bf16_f32 v70, v44, v45
    v_cvt_pk_bf16_f32 v71, v46, v47
    s_waitcnt lgkmcnt(2)
    v_mfma_f32_32x32x16_bf16 v[32:47], v[80:83], v[112:115], v[96:111]
    v_exp_f32 v16, v16
    v_exp_f32 v17, v17
    v_exp_f32 v18, v18
    v_exp_f32 v19, v19
    v_mfma_f32_32x32x16_bf16 v[48:63], v[124:127], v[68:71], v[48:63]
    ds_read_b128 v[72:75], v14 offset:0
    ds_read_b128 v[76:79], v14 offset:1024
    s_cmp_lg_u32 s39, 1
    s_cbranch_scc1 L_o_14
    s_add_u32 s52, s54, 86016
    buffer_load_dwordx4 v[220:223], v3, s[24:27], s52 offen sc1
L_o_14:
    v_exp_f32 v20, v20
    v_exp_f32 v21, v21
    v_exp_f32 v22, v22
    v_exp_f32 v23, v23
    v_mfma_f32_32x32x16_bf16 v[32:47], v[84:87], v[116:119], v[32:47]
    s_add_u32 m0, s47, 0
    s_add_u32 s51, s53, 0
    buffer_load_dwordx4 v15, s[28:31], s51 offen lds
    v_cvt_pk_bf16_f32 v64, v16, v17
    v_cvt_pk_bf16_f32 v65, v18, v19
    v_cvt_pk_bf16_f32 v66, v20, v21
    v_cvt_pk_bf16_f32 v67, v22, v23
    ds_read_b128 v[120:123], v13 offset:59392
    ds_read_b128 v[124:127], v13 offset:60416
    v_exp_f32 v24, v24
    v_exp_f32 v25, v25
    v_exp_f32 v26, v26
    v_exp_f32 v27, v27
    s_waitcnt lgkmcnt(4)
    v_mfma_f32_32x32x16_bf16 v[48:63], v[88:91], v[64:67], v[48:63]
    s_add_u32 m0, s47, 8192
    s_add_u32 s51, s53, 57344
    buffer_load_dwordx4 v15, s[28:31], s51 offen lds
    v_exp_f32 v28, v28
    v_exp_f32 v29, v29
    v_exp_f32 v30, v30
    v_exp_f32 v31, v31
    v_cvt_pk_bf16_f32 v68, v24, v25
    v_cvt_pk_bf16_f32 v69, v26, v27
    v_cvt_pk_bf16_f32 v70, v28, v29
    v_cvt_pk_bf16_f32 v71, v30, v31
    s_waitcnt lgkmcnt(2)
    v_mfma_f32_32x32x16_bf16 v[16:31], v[72:75], v[112:115], v[96:111]
    v_exp_f32 v32, v32
    v_exp_f32 v33, v33
    v_exp_f32 v34, v34
    v_exp_f32 v35, v35
    v_mfma_f32_32x32x16_bf16 v[48:63], v[92:95], v[68:71], v[48:63]
    ds_read_b128 v[80:83], v14 offset:8192
    ds_read_b128 v[84:87], v14 offset:9216
    s_cmp_lg_u32 s39, 1
    s_cbranch_scc1 L_o_15
    s_add_u32 s52, s54, 87040
    buffer_load_dwordx4 v[224:227], v3, s[24:27], s52 offen sc1
L_o_15:
    s_cmp_lg_u32 s39, 1
    s_cbranch_scc1 L_o_16
    s_add_u32 s52, s54, 88064
    buffer_load_dwordx4 v[228:231], v3, s[24:27], s52 offen sc1
L_o_16:
    v_exp_f32 v36, v36
    v_exp_f32 v37, v37
    v_exp_f32 v38, v38
    v_exp_f32 v39, v39
    v_mfma_f32_32x32x16_bf16 v[16:31], v[76:79], v[116:119], v[16:31]
    s_add_u32 m0, s47, 16384
    s_add_u32 s51, s53, 114688
    buffer_load_dwordx4 v15, s[28:31], s51 offen lds
    v_cvt_pk_bf16_f32 v64, v32, v33
    v_cvt_pk_bf16_f32 v65, v34, v35
    v_cvt_pk_bf16_f32 v66, v36, v37
    v_cvt_pk_bf16_f32 v67, v38, v39
    ds_read_b128 v[88:91], v14 offset:2048
    ds_read_b128 v[92:95], v14 offset:3072
    v_exp_f32 v40, v40
    v_exp_f32 v41, v41
    v_exp_f32 v42, v42
    v_exp_f32 v43, v43
    s_waitcnt lgkmcnt(4)
    v_mfma_f32_32x32x16_bf16 v[48:63], v[120:123], v[64:67], v[48:63]
    s_add_u32 m0, s47, 24576
    s_add_u32 s51, s53, 172032
    buffer_load_dwordx4 v15, s[28:31], s51 offen lds
    v_exp_f32 v44, v44
    v_exp_f32 v45, v45
    v_exp_f32 v46, v46
    v_exp_f32 v47, v47
    v_cvt_pk_bf16_f32 v68, v40, v41
    v_cvt_pk_bf16_f32 v69, v42, v43
    v_cvt_pk_bf16_f32 v70, v44, v45
    v_cvt_pk_bf16_f32 v71, v46, v47
    s_setprio 2
    s_waitcnt lgkmcnt(2)
    v_mfma_f32_32x32x16_bf16 v[32:47], v[80:83], v[112:115], v[96:111]
    v_exp_f32 v16, v16
    v_exp_f32 v17, v17
    v_exp_f32 v18, v18
    v_exp_f32 v19, v19
    v_mfma_f32_32x32x16_bf16 v[48:63], v[124:127], v[68:71], v[48:63]
    ds_read_b128 v[72:75], v14 offset:16384
    ds_read_b128 v[76:79], v14 offset:17408
    s_cmp_lg_u32 s39, 1
    s_cbranch_scc1 L_o_17
    s_add_u32 s52, s54, 89088
    buffer_load_dwordx4 v[232:235], v3, s[24:27], s52 offen sc1
L_o_17:
    s_cmp_lg_u32 s39, 1
    s_cbranch_scc1 L_o_18
    s_add_u32 s52, s54, 90112
    buffer_load_dwordx4 v[236:239], v3, s[24:27], s52 offen sc1
L_o_18:
    v_exp_f32 v20, v20
    v_exp_f32 v21, v21
    v_exp_f32 v22, v22
    v_exp_f32 v23, v23
    v_mfma_f32_32x32x16_bf16 v[32:47], v[84:87], v[116:119], v[32:47]
    s_add_u32 m0, s47, 32768
    s_add_u32 s51, s53, 229376
    buffer_load_dwordx4 v15, s[28:31], s51 offen lds
    v_cvt_pk_bf16_f32 v64, v16, v17
    v_cvt_pk_bf16_f32 v65, v18, v19
    v_cvt_pk_bf16_f32 v66, v20, v21
    v_cvt_pk_bf16_f32 v67, v22, v23
    ds_read_b128 v[120:123], v14 offset:10240
    ds_read_b128 v[124:127], v14 offset:11264
    v_exp_f32 v24, v24
    v_exp_f32 v25, v25
    v_exp_f32 v26, v26
    v_exp_f32 v27, v27
    s_waitcnt lgkmcnt(4)
    v_mfma_f32_32x32x16_bf16 v[48:63], v[88:91], v[64:67], v[48:63]
    s_cmp_lg_u32 s39, 0
    s_cbranch_scc1 L_o_19
    s_mov_b32 s32, s4
    s_mov_b32 s33, s5
    s_mov_b32 s34, 1835008
    s_mov_b32 s35, 0x20000
    buffer_load_dwordx4 v[240:243], v128, s[32:35], s55 offen
    buffer_load_dwordx4 v[244:247], v128, s[32:35], s55 offen offset:16
L_o_19:
    v_exp_f32 v28, v28
    v_exp_f32 v29, v29
    v_exp_f32 v30, v30
    v_exp_f32 v31, v31
    v_cvt_pk_bf16_f32 v68, v24, v25
    v_cvt_pk_bf16_f32 v69, v26, v27
    v_cvt_pk_bf16_f32 v70, v28, v29
    v_cvt_pk_bf16_f32 v71, v30, v31
    s_waitcnt lgkmcnt(2)
    v_mfma_f32_32x32x16_bf16 v[16:31], v[72:75], v[112:115], v[96:111]
    v_exp_f32 v32, v32
    v_exp_f32 v33, v33
    v_exp_f32 v34, v34
    v_exp_f32 v35, v35
    v_mfma_f32_32x32x16_bf16 v[48:63], v[92:95], v[68:71], v[48:63]
    ds_read_b128 v[80:83], v14 offset:24576
    ds_read_b128 v[84:87], v14 offset:25600
    s_add_u32 s52, s54, 62464
    buffer_load_dwordx4 v[212:215], v3, s[24:27], s52 offen sc1
    v_exp_f32 v36, v36
    v_exp_f32 v37, v37
    v_exp_f32 v38, v38
    v_exp_f32 v39, v39
    v_mfma_f32_32x32x16_bf16 v[16:31], v[76:79], v[116:119], v[16:31]
    v_cvt_pk_bf16_f32 v64, v32, v33
    v_cvt_pk_bf16_f32 v65, v34, v35
    v_cvt_pk_bf16_f32 v66, v36, v37
    v_cvt_pk_bf16_f32 v67, v38, v39
    ds_read_b128 v[88:91], v14 offset:18432
    ds_read_b128 v[92:95], v14 offset:19456
    v_exp_f32 v40, v40
    v_exp_f32 v41, v41
    v_exp_f32 v42, v42
    v_exp_f32 v43, v43
    s_waitcnt lgkmcnt(4)
    v_mfma_f32_32x32x16_bf16 v[48:63], v[120:123], v[64:67], v[48:63]
    v_exp_f32 v44, v44
    v_exp_f32 v45, v45
    v_exp_f32 v46, v46
    v_exp_f32 v47, v47
    v_cvt_pk_bf16_f32 v68, v40, v41
    v_cvt_pk_bf16_f32 v69, v42, v43
    v_cvt_pk_bf16_f32 v70, v44, v45
    v_cvt_pk_bf16_f32 v71, v46, v47
    s_setprio 1
    s_waitcnt lgkmcnt(2)
    v_mfma_f32_32x32x16_bf16 v[32:47], v[80:83], v[112:115], v[96:111]
    v_exp_f32 v16, v16
    v_exp_f32 v17, v17
    v_exp_f32 v18, v18
    v_exp_f32 v19, v19
    v_mfma_f32_32x32x16_bf16 v[48:63], v[124:127], v[68:71], v[48:63]
    ds_read_b128 v[72:75], v14 offset:32768
    ds_read_b128 v[76:79], v14 offset:33792
    s_add_u32 s52, s54, 63488
    buffer_load_dwordx4 v[216:219], v3, s[24:27], s52 offen sc1
    v_exp_f32 v20, v20
    v_exp_f32 v21, v21
    v_exp_f32 v22, v22
    v_exp_f32 v23, v23
    v_mfma_f32_32x32x16_bf16 v[32:47], v[84:87], v[116:119], v[32:47]
    v_cvt_pk_bf16_f32 v64, v16, v17
    v_cvt_pk_bf16_f32 v65, v18, v19
    v_cvt_pk_bf16_f32 v66, v20, v21
    v_cvt_pk_bf16_f32 v67, v22, v23
    ds_read_b128 v[120:123], v14 offset:26624
    ds_read_b128 v[124:127], v14 offset:27648
    v_exp_f32 v24, v24
    v_exp_f32 v25, v25
    v_exp_f32 v26, v26
    v_exp_f32 v27, v27
    s_waitcnt lgkmcnt(4)
    v_mfma_f32_32x32x16_bf16 v[48:63], v[88:91], v[64:67], v[48:63]
    v_exp_f32 v28, v28
    v_exp_f32 v29, v29
    v_exp_f32 v30, v30
    v_exp_f32 v31, v31
    v_cvt_pk_bf16_f32 v68, v24, v25
    v_cvt_pk_bf16_f32 v69, v26, v27
    v_cvt_pk_bf16_f32 v70, v28, v29
    v_cvt_pk_bf16_f32 v71, v30, v31
    s_setprio 0
    s_waitcnt lgkmcnt(2)
    v_mfma_f32_32x32x16_bf16 v[16:31], v[72:75], v[112:115], v[96:111]
    v_exp_f32 v32, v32
    v_exp_f32 v33, v33
    v_exp_f32 v34, v34
    v_exp_f32 v35, v35
    v_mfma_f32_32x32x16_bf16 v[48:63], v[92:95], v[68:71], v[48:63]
    ds_read_b128 v[80:83], v14 offset:40960
    ds_read_b128 v[84:87], v14 offset:41984
    s_cmp_lg_u32 s39, 1
    s_cbranch_scc1 L_o_20
    s_add_u32 s52, s54, 91136
    buffer_load_dwordx4 v[240:243], v3, s[24:27], s52 offen sc1
L_o_20:
    s_cmp_lg_u32 s39, 1
    s_cbranch_scc1 L_o_21
    s_add_u32 s52, s54, 92160
    buffer_load_dwordx4 v[244:247], v3, s[24:27], s52 offen sc1
L_o_21:
    v_exp_f32 v36, v36
    v_exp_f32 v37, v37
    v_exp_f32 v38, v38
    v_exp_f32 v39, v39
    v_mfma_f32_32x32x16_bf16 v[16:31], v[76:79], v[116:119], v[16:31]
    v_cvt_pk_bf16_f32 v64, v32, v33
    v_cvt_pk_bf16_f32 v65, v34, v35
    v_cvt_pk_bf16_f32 v66, v36, v37
    v_cvt_pk_bf16_f32 v67, v38, v39
    ds_read_b128 v[88:91], v14 offset:34816
    ds_read_b128 v[92:95], v14 offset:35840
    v_exp_f32 v40, v40
    v_exp_f32 v41, v41
    v_exp_f32 v42, v42
    v_exp_f32 v43, v43
    s_waitcnt lgkmcnt(4)
    v_mfma_f32_32x32x16_bf16 v[48:63], v[120:123], v[64:67], v[48:63]
    v_exp_f32 v44, v44
    v_exp_f32 v45, v45
    v_exp_f32 v46, v46
    v_exp_f32 v47, v47
    v_cvt_pk_bf16_f32 v68, v40, v41
    v_cvt_pk_bf16_f32 v69, v42, v43
    v_cvt_pk_bf16_f32 v70, v44, v45
    v_cvt_pk_bf16_f32 v71, v46, v47
    s_waitcnt vmcnt(7)
    s_barrier
    s_setprio 3
    s_waitcnt lgkmcnt(2)
    v_mfma_f32_32x32x16_bf16 v[32:47], v[80:83], v[112:115], v[96:111]
    v_exp_f32 v16, v16
    v_exp_f32 v17, v17
    v_exp_f32 v18, v18
    v_exp_f32 v19, v19
    v_mfma_f32_32x32x16_bf16 v[48:63], v[124:127], v[68:71], v[48:63]
    ds_read_b128 v[72:75], v14 offset:49152
    ds_read_b128 v[76:79], v14 offset:50176
    s_cmp_lg_u32 s39, 1
    s_cbranch_scc1 L_o_22
    buffer_load_dwordx4 v[248:251], v3, s[24:27], s46 offen offset:0 sc1
L_o_22:
    v_exp_f32 v20, v20
    v_exp_f32 v21, v21
    v_exp_f32 v22, v22
    v_exp_f32 v23, v23
    v_mfma_f32_32x32x16_bf16 v[32:47], v[84:87], v[116:119], v[32:47]
    s_add_u32 m0, s47, 40960
    s_add_u32 s51, s53, 286720
    buffer_load_dwordx4 v15, s[28:31], s51 offen lds
    v_cvt_pk_bf16_f32 v64, v16, v17
    v_cvt_pk_bf16_f32 v65, v18, v19
    v_cvt_pk_bf16_f32 v66, v20, v21
    v_cvt_pk_bf16_f32 v67, v22, v23
    ds_read_b128 v[120:123], v14 offset:43008
    ds_read_b128 v[124:127], v14 offset:44032
    v_exp_f32 v24, v24
    v_exp_f32 v25, v25
    v_exp_f32 v26, v26
    v_exp_f32 v27, v27
    s_waitcnt lgkmcnt(4)
    v_mfma_f32_32x32x16_bf16 v[48:63], v[88:91], v[64:67], v[48:63]
    s_add_u32 m0, s47, 49152
    s_add_u32 s51, s53, 344064
    buffer_load_dwordx4 v15, s[28:31], s51 offen lds
    v_exp_f32 v28, v28
    v_exp_f32 v29, v29
    v_exp_f32 v30, v30
    v_exp_f32 v31, v31
    v_cvt_pk_bf16_f32 v68, v24, v25
    v_cvt_pk_bf16_f32 v69, v26, v27
    v_cvt_pk_bf16_f32 v70, v28, v29
    v_cvt_pk_bf16_f32 v71, v30, v31
    s_setprio 2
    s_waitcnt lgkmcnt(2)
    v_mfma_f32_32x32x16_bf16 v[16:31], v[72:75], v[112:115], v[96:111]
    v_exp_f32 v32, v32
    v_exp_f32 v33, v33
    v_exp_f32 v34, v34
    v_exp_f32 v35, v35
    v_mfma_f32_32x32x16_bf16 v[48:63], v[92:95], v[68:71], v[48:63]
    ds_read_b128 v[80:83], v14 offset:57344
    ds_read_b128 v[84:87], v14 offset:58368
    s_cmp_lg_u32 s39, 1
    s_cbranch_scc1 L_o_23
    buffer_load_dwordx4 v[252:255], v3, s[24:27], s46 offen offset:1024 sc1
L_o_23:
    v_exp_f32 v36, v36
    v_exp_f32 v37, v37
    v_exp_f32 v38, v38
    v_exp_f32 v39, v39
    v_mfma_f32_32x32x16_bf16 v[16:31], v[76:79], v[116:119], v[16:31]
    ds_write_b64 v10, v[130:131] offset:57344
    v_cvt_pk_bf16_f32 v64, v32, v33
    v_cvt_pk_bf16_f32 v65, v34, v35
    v_cvt_pk_bf16_f32 v66, v36, v37
    v_cvt_pk_bf16_f32 v67, v38, v39
    ds_read_b128 v[88:91], v14 offset:51200
    ds_read_b128 v[92:95], v14 offset:52224
    v_exp_f32 v40, v40
    v_exp_f32 v41, v41
    v_exp_f32 v42, v42
    v_exp_f32 v43, v43
    s_waitcnt lgkmcnt(5)
    v_mfma_f32_32x32x16_bf16 v[48:63], v[120:123], v[64:67], v[48:63]
    v_exp_f32 v44, v44
    v_exp_f32 v45, v45
    v_exp_f32 v46, v46
    v_exp_f32 v47, v47
    v_cvt_pk_bf16_f32 v68, v40, v41
    v_cvt_pk_bf16_f32 v69, v42, v43
    v_cvt_pk_bf16_f32 v70, v44, v45
    v_cvt_pk_bf16_f32 v71, v46, v47
    s_setprio 1
    s_waitcnt lgkmcnt(3)
    v_mfma_f32_32x32x16_bf16 v[32:47], v[80:83], v[112:115], v[96:111]
    v_exp_f32 v16, v16
    v_exp_f32 v17, v17
    v_exp_f32 v18, v18
    v_exp_f32 v19, v19
    v_mfma_f32_32x32x16_bf16 v[48:63], v[124:127], v[68:71], v[48:63]
    v_exp_f32 v20, v20
    v_exp_f32 v21, v21
    v_exp_f32 v22, v22
    v_exp_f32 v23, v23
    v_mfma_f32_32x32x16_bf16 v[32:47], v[84:87], v[116:119], v[32:47]
    v_cvt_pk_bf16_f32 v64, v16, v17
    v_cvt_pk_bf16_f32 v65, v18, v19
    v_cvt_pk_bf16_f32 v66, v20, v21
    v_cvt_pk_bf16_f32 v67, v22, v23
    ds_read_b128 v[120:123], v14 offset:59392
    ds_read_b128 v[124:127], v14 offset:60416
    v_exp_f32 v24, v24
    v_exp_f32 v25, v25
    v_exp_f32 v26, v26
    v_exp_f32 v27, v27
    s_waitcnt lgkmcnt(2)
    v_mfma_f32_32x32x16_bf16 v[48:63], v[88:91], v[64:67], v[48:63]
    v_exp_f32 v28, v28
    v_exp_f32 v29, v29
    v_exp_f32 v30, v30
    v_exp_f32 v31, v31
    v_cvt_pk_bf16_f32 v68, v24, v25
    v_cvt_pk_bf16_f32 v69, v26, v27
    v_cvt_pk_bf16_f32 v70, v28, v29
    v_cvt_pk_bf16_f32 v71, v30, v31
    s_setprio 0
    v_exp_f32 v32, v32
    v_exp_f32 v33, v33
    v_exp_f32 v34, v34
    v_exp_f32 v35, v35
    v_mfma_f32_32x32x16_bf16 v[48:63], v[92:95], v[68:71], v[48:63]
    v_exp_f32 v36, v36
    v_exp_f32 v37, v37
    v_exp_f32 v38, v38
    v_exp_f32 v39, v39
    v_cvt_pk_bf16_f32 v64, v32, v33
    v_cvt_pk_bf16_f32 v65, v34, v35
    v_cvt_pk_bf16_f32 v66, v36, v37
    v_cvt_pk_bf16_f32 v67, v38, v39
    v_exp_f32 v40, v40
    v_exp_f32 v41, v41
    v_exp_f32 v42, v42
    v_exp_f32 v43, v43
    s_waitcnt lgkmcnt(0)
    v_mfma_f32_32x32x16_bf16 v[48:63], v[120:123], v[64:67], v[48:63]
    v_exp_f32 v44, v44
    v_exp_f32 v45, v45
    v_exp_f32 v46, v46
    v_exp_f32 v47, v47
    v_cvt_pk_bf16_f32 v68, v40, v41
    v_cvt_pk_bf16_f32 v69, v42, v43
    v_cvt_pk_bf16_f32 v70, v44, v45
    v_cvt_pk_bf16_f32 v71, v46, v47
    s_nop 1
    v_mfma_f32_32x32x16_bf16 v[48:63], v[124:127], v[68:71], v[48:63]
    s_mul_i32 s51, s3, 2304
    s_xor_b32 s52, s3, 4
    s_mul_i32 s52, s52, 2304
    s_add_u32 s51, s51, 135168
    s_add_u32 s52, s52, 135168
    v_add_u32 v6, s51, v3
    v_add_u32 v7, s52, v3
    v_lshlrev_b32 v8, 2, v0
    v_add_u32 v9, s52, v8
    v_add_u32 v8, s51, v8
    s_mov_b32 s51, 0x71800000
    s_cmp_lg_u32 s39, 0
    ds_write_b32 v8, v60 offset:2048
    s_cbranch_scc1 L_h1_24
    ds_write_b128 v6, v[56:59]
    ds_write_b128 v6, v[60:63] offset:1024
    s_branch L_h2_28
L_h1_24:
    ds_write_b128 v6, v[48:51]
    ds_write_b128 v6, v[52:55] offset:1024
L_h2_28:
    v_pk_add_f32 v[18:19], v[48:49], v[50:51]
    v_pk_add_f32 v[18:19], v[18:19], v[52:53]
    v_pk_add_f32 v[18:19], v[18:19], v[54:55]
    v_pk_add_f32 v[18:19], v[18:19], v[56:57]
    v_pk_add_f32 v[18:19], v[18:19], v[58:59]
    v_pk_add_f32 v[18:19], v[18:19], v[60:61]
    v_pk_add_f32 v[18:19], v[18:19], v[62:63]
    v_add_f32 v18, v18, v19
    v_fma_f32 v18, v18, 0, |v60|
    v_cmp_nle_f32 vcc, v18, s51
    v_mov_b32 v16, 153600
    v_mov_b32 v17, 1
    s_cbranch_vccz L_ok_26
    ds_write_b32 v16, v17
L_ok_26:
    s_cbranch_scc0 L_hj_25
    v_pk_mov_b32 v[48:49], v[56:57], v[56:57] op_sel:[0,1]
    v_pk_mov_b32 v[50:51], v[58:59], v[58:59] op_sel:[0,1]
    v_pk_mov_b32 v[52:53], v[60:61], v[60:61] op_sel:[0,1]
    v_pk_mov_b32 v[54:55], v[62:63], v[62:63] op_sel:[0,1]
L_hj_25:
    s_waitcnt lgkmcnt(0)
    s_barrier
    ds_read_b32 v16, v16
    ds_read_b32 v17, v9 offset:2048
    ds_read_b128 v[20:23], v7
    ds_read_b128 v[24:27], v7 offset:1024
    s_lshl_b32 s51, s39, 5
    s_sub_u32 s51, 64, s51
    s_lshl_b32 s52, s42, 4
    s_add_u32 s52, s52, s40
    s_lshl_b32 s52, s52, 1
    s_add_u32 s52, s52, s39
    s_lshl_b32 s52, s52, 10
    s_add_u32 s52, s52, 5505024
    s_waitcnt lgkmcnt(2)
    v_cmp_lt_u32 vcc, s50, v16
    v_add_f32 v17, v17, v60
    v_mov_b32 v16, v17
    s_cbranch_vccz L_fin_27
    s_waitcnt vmcnt(0) lgkmcnt(0)
    s_barrier
    v_mov_b32 v16, 0x3f803f80
    v_mov_b32 v17, v16
    v_mov_b32 v18, v16
    v_mov_b32 v19, v16
    v_and_b32 v6, 3, v0
    v_lshlrev_b32 v6, 4, v6
    v_bfe_u32 v7, v0, 2, 2
    v_lshl_add_u32 v6, v7, 9, v6
    v_lshrrev_b32 v7, 4, v0
    v_lshl_add_u32 v6, v7, 12, v6
    s_lshl_b32 s51, s3, 14
    v_add_u32 v6, s51, v6
    ds_write_b128 v6, v[16:19] offset:2496
    s_mov_b32 s50, 1
    s_mov_b32 s51, s44
    s_mov_b32 s52, 64
    v_mov_b32 v6, 0xff800000
L_mx_29:
    buffer_load_dwordx4 v[72:75], v3, s[24:27], s51 offen offset:0 sc1
    buffer_load_dwordx4 v[76:79], v3, s[24:27], s51 offen offset:1024 sc1
    s_waitcnt vmcnt(0)
    v_mfma_f32_32x32x16_bf16 v[32:47], v[72:75], v[112:115], 0
    v_mfma_f32_32x32x16_bf16 v[32:47], v[76:79], v[116:119], v[32:47]
    s_nop 11
    v_max3_f32 v6, v6, v32, v33
    v_max3_f32 v6, v6, v34, v35
    v_max3_f32 v6, v6, v36, v37
    v_max3_f32 v6, v6, v38, v39
    v_max3_f32 v6, v6, v40, v41
    v_max3_f32 v6, v6, v42, v43
    v_max3_f32 v6, v6, v44, v45
    v_max3_f32 v6, v6, v46, v47
    s_add_u32 s51, s51, 28672
    s_sub_u32 s52, s52, 1
    s_cmp_lg_u32 s52, 0
    s_cbranch_scc1 L_mx_29
    v_mov_b32 v7, v6
    s_nop 1
    v_permlane32_swap_b32 v6, v7
    s_nop 1
    v_max_f32 v6, v6, v7
    v_sub_f32 v96, 0, v6
    v_sub_f32 v97, 0, v6
    v_sub_f32 v98, 0, v6
    v_sub_f32 v99, 0, v6
    v_sub_f32 v100, 0, v6
    v_sub_f32 v101, 0, v6
    v_sub_f32 v102, 0, v6
    v_sub_f32 v103, 0, v6
    v_sub_f32 v104, 0, v6
    v_sub_f32 v105, 0, v6
    v_sub_f32 v106, 0, v6
    v_sub_f32 v107, 0, v6
    v_sub_f32 v108, 0, v6
    v_sub_f32 v109, 0, v6
    v_sub_f32 v110, 0, v6
    v_sub_f32 v111, 0, v6
    s_waitcnt lgkmcnt(0)
    s_branch L_top_10
L_tsl_12:
    v_mov_b32 v4, v129
    s_mov_b32 s58, 0x100000
    s_mov_b32 s59, 20447232
L_poll_30:
    buffer_load_dword v5, v4, s[24:27], s59 offen sc1
    s_sub_u32 s58, s58, 1
    s_cmp_eq_u32 s58, 0
    s_cbranch_scc1 L_polld_31
    s_waitcnt vmcnt(0)
    v_cmp_gt_u32 vcc, 1, v5
    s_nop 0
    s_cbranch_vccnz L_poll_30
L_polld_31:
    s_branch L_tbk_13
L_fin_27:
    s_nop 0
    v_permlane32_swap_b32 v17, v16
    v_cmp_gt_u32 vcc, s51, v0
    v_rcp_f32 v16, v16
    s_waitcnt lgkmcnt(0)
    v_pk_add_f32 v[20:21], v[20:21], v[48:49]
    v_pk_add_f32 v[22:23], v[22:23], v[50:51]
    v_pk_add_f32 v[24:25], v[24:25], v[52:53]
    v_pk_add_f32 v[26:27], v[26:27], v[54:55]
    v_pk_mul_f32 v[20:21], v[20:21], v[16:17] op_sel_hi:[1,0]
    v_pk_mul_f32 v[22:23], v[22:23], v[16:17] op_sel_hi:[1,0]
    v_pk_mul_f32 v[24:25], v[24:25], v[16:17] op_sel_hi:[1,0]
    v_pk_mul_f32 v[26:27], v[26:27], v[16:17] op_sel_hi:[1,0]
    v_cvt_pk_bf16_f32 v28, v20, v21
    v_cvt_pk_bf16_f32 v29, v22, v23
    v_cvt_pk_bf16_f32 v30, v24, v25
    v_cvt_pk_bf16_f32 v31, v26, v27
    v_cndmask_b32 v30, 0, v30, vcc
    v_cndmask_b32 v31, 0, v31, vcc
    buffer_store_dwordx4 v[28:31], v3, s[24:27], s52 offen sc1
    s_mul_i32 s51, s38, 7168
    v_add_u32 v6, s51, v3
    v_add_u32 v7, 77824, v6
    s_cmp_lg_u32 s39, 0
    s_cbranch_scc1 L_LD
    s_waitcnt vmcnt(1)
    ds_write_b128 v7, v[136:139] offset:0
    ds_write_b128 v7, v[140:143] offset:1024
    ds_write_b128 v7, v[144:147] offset:2048
    ds_write_b128 v7, v[148:151] offset:3072
    ds_write_b128 v7, v[152:155] offset:4096
    ds_write_b128 v7, v[156:159] offset:5120
    ds_write_b128 v7, v[160:163] offset:6144
    ds_write_b128 v7, v[164:167] offset:28672
    s_waitcnt vmcnt(0)
    s_barrier
    ds_write_b128 v7, v[168:171] offset:29696
    ds_write_b128 v7, v[172:175] offset:30720
    ds_write_b128 v7, v[176:179] offset:31744
    ds_write_b128 v7, v[180:183] offset:32768
    ds_write_b128 v7, v[184:187] offset:33792
    ds_write_b128 v7, v[188:191] offset:34816
    ds_write_b128 v7, v[192:195] offset:57344
    ds_write_b128 v7, v[196:199] offset:58368
    ds_write_b128 v7, v[200:203] offset:59392
    ds_write_b128 v7, v[204:207] offset:60416
    ds_write_b128 v7, v[208:211] offset:61440
    ds_write_b128 v7, v[212:215] offset:62464
    ds_write_b128 v7, v[216:219] offset:63488
    s_lshl_b32 s40, s36, 2
    s_and_b32 s41, s37, 3
    s_add_u32 s40, s40, s41
    s_lshr_b32 s41, s37, 2
    s_and_b32 s42, s3, 1
    s_bfe_u32 s43, s3, 0x10001
    s_lshl_b32 s44, s40, 1
    s_add_u32 s44, s44, s42
    s_lshl_b32 s45, s41, 1
    s_add_u32 s45, s45, s43
    s_cmp_ge_u32 s2, 224
    s_cbranch_scc1 L_C3E
    v_bfe_u32 v5, v0, 2, 2
    v_mul_u32_u24 v6, 4, v1
    v_add_u32 v6, v6, v5
    v_lshlrev_b32 v6, 7, v6
    v_and_b32 v7, 1, v0
    v_lshlrev_b32 v7, 5, v7
    v_bfe_u32 v8, v0, 4, 1
    v_lshl_add_u32 v7, v8, 4, v7
    v_bfe_u32 v8, v0, 1, 1
    v_lshl_add_u32 v7, v8, 3, v7
    v_lshrrev_b32 v5, 1, v5
    v_lshl_add_u32 v7, v5, 6, v7
    v_add_u32 v10, v6, v7
    v_xor_b32 v11, 64, v10
    s_mul_i32 s46, s43, 28672
    s_add_u32 s46, s46, 0
    v_add_u32 v10, s46, v10
    v_add_u32 v11, s46, v11
    s_lshl_b32 s46, s44, 15
    s_lshl_b32 s47, s43, 14
    s_add_u32 s46, s46, s47
    s_add_u32 s46, s46, 5505024
    ds_read_b64_tr_b16 v[220:221], v10 offset:0
    ds_read_b64_tr_b16 v[222:223], v10 offset:1024
    ds_read_b64_tr_b16 v[224:225], v11 offset:0
    ds_read_b64_tr_b16 v[226:227], v11 offset:1024
    ds_read_b64_tr_b16 v[228:229], v10 offset:2048
    ds_read_b64_tr_b16 v[230:231], v10 offset:3072
    ds_read_b64_tr_b16 v[232:233], v11 offset:2048
    ds_read_b64_tr_b16 v[234:235], v11 offset:3072
    s_barrier
    buffer_load_dwordx4 v[80:83], v3, s[24:27], s46 offen offset:0 sc1
    buffer_load_dwordx4 v[84:87], v3, s[24:27], s46 offen offset:1024 sc1
    buffer_load_dwordx4 v[88:91], v3, s[24:27], s46 offen offset:2048 sc1
    buffer_load_dwordx4 v[92:95], v3, s[24:27], s46 offen offset:3072 sc1
    s_add_u32 s46, s46, 4096
    buffer_load_dwordx4 v[96:99], v3, s[24:27], s46 offen offset:0 sc1
    buffer_load_dwordx4 v[100:103], v3, s[24:27], s46 offen offset:1024 sc1
    buffer_load_dwordx4 v[104:107], v3, s[24:27], s46 offen offset:2048 sc1
    buffer_load_dwordx4 v[108:111], v3, s[24:27], s46 offen offset:3072 sc1
    s_add_u32 s46, s46, 4096
    buffer_load_dwordx4 v[112:115], v3, s[24:27], s46 offen offset:0 sc1
    buffer_load_dwordx4 v[116:119], v3, s[24:27], s46 offen offset:1024 sc1
    buffer_load_dwordx4 v[120:123], v3, s[24:27], s46 offen offset:2048 sc1
    buffer_load_dwordx4 v[124:127], v3, s[24:27], s46 offen offset:3072 sc1
    s_add_u32 s46, s46, 4096
    buffer_load_dwordx4 v[128:131], v3, s[24:27], s46 offen offset:0 sc1
    buffer_load_dwordx4 v[132:135], v3, s[24:27], s46 offen offset:1024 sc1
    buffer_load_dwordx4 v[136:139], v3, s[24:27], s46 offen offset:2048 sc1
    buffer_load_dwordx4 v[140:143], v3, s[24:27], s46 offen offset:3072 sc1
    s_waitcnt vmcnt(15) lgkmcnt(4)
    v_mfma_f32_32x32x16_bf16 v[16:31], v[220:223], v[80:83], 0
    ds_read_b64_tr_b16 v[64:65], v10 offset:3584
    ds_read_b64_tr_b16 v[66:67], v10 offset:4608
    v_mfma_f32_32x32x16_bf16 v[32:47], v[224:227], v[80:83], 0
    ds_read_b64_tr_b16 v[68:69], v11 offset:3584
    ds_read_b64_tr_b16 v[70:71], v11 offset:4608
    s_waitcnt vmcnt(14) lgkmcnt(4)
    v_mfma_f32_32x32x16_bf16 v[16:31], v[228:231], v[84:87], v[16:31]
    ds_read_b64_tr_b16 v[220:221], v10 offset:5632
    ds_read_b64_tr_b16 v[222:223], v10 offset:6656
    v_mfma_f32_32x32x16_bf16 v[32:47], v[232:235], v[84:87], v[32:47]
    ds_read_b64_tr_b16 v[224:225], v11 offset:5632
    ds_read_b64_tr_b16 v[226:227], v11 offset:6656
    s_waitcnt vmcnt(13) lgkmcnt(4)
    v_mfma_f32_32x32x16_bf16 v[16:31], v[64:67], v[88:91], v[16:31]
    ds_read_b64_tr_b16 v[228:229], v10 offset:7168
    ds_read_b64_tr_b16 v[230:231], v10 offset:8192
    v_mfma_f32_32x32x16_bf16 v[32:47], v[68:71], v[88:91], v[32:47]
    ds_read_b64_tr_b16 v[232:233], v11 offset:7168
    ds_read_b64_tr_b16 v[234:235], v11 offset:8192
    s_waitcnt vmcnt(12) lgkmcnt(4)
    v_mfma_f32_32x32x16_bf16 v[16:31], v[220:223], v[92:95], v[16:31]
    ds_read_b64_tr_b16 v[64:65], v10 offset:9216
    ds_read_b64_tr_b16 v[66:67], v10 offset:10240
    v_mfma_f32_32x32x16_bf16 v[32:47], v[224:227], v[92:95], v[32:47]
    ds_read_b64_tr_b16 v[68:69], v11 offset:9216
    ds_read_b64_tr_b16 v[70:71], v11 offset:10240
    s_waitcnt vmcnt(11) lgkmcnt(4)
    v_mfma_f32_32x32x16_bf16 v[16:31], v[228:231], v[96:99], v[16:31]
    ds_read_b64_tr_b16 v[220:221], v10 offset:10752
    ds_read_b64_tr_b16 v[222:223], v10 offset:11776
    v_mfma_f32_32x32x16_bf16 v[32:47], v[232:235], v[96:99], v[32:47]
    ds_read_b64_tr_b16 v[224:225], v11 offset:10752
    ds_read_b64_tr_b16 v[226:227], v11 offset:11776
    s_waitcnt vmcnt(10) lgkmcnt(4)
    v_mfma_f32_32x32x16_bf16 v[16:31], v[64:67], v[100:103], v[16:31]
    ds_read_b64_tr_b16 v[228:229], v10 offset:12800
    ds_read_b64_tr_b16 v[230:231], v10 offset:13824
    v_mfma_f32_32x32x16_bf16 v[32:47], v[68:71], v[100:103], v[32:47]
    ds_read_b64_tr_b16 v[232:233], v11 offset:12800
    ds_read_b64_tr_b16 v[234:235], v11 offset:13824
    s_waitcnt vmcnt(9) lgkmcnt(4)
    v_mfma_f32_32x32x16_bf16 v[16:31], v[220:223], v[104:107], v[16:31]
    ds_read_b64_tr_b16 v[64:65], v10 offset:14336
    ds_read_b64_tr_b16 v[66:67], v10 offset:15360
    v_mfma_f32_32x32x16_bf16 v[32:47], v[224:227], v[104:107], v[32:47]
    ds_read_b64_tr_b16 v[68:69], v11 offset:14336
    ds_read_b64_tr_b16 v[70:71], v11 offset:15360
    s_waitcnt vmcnt(8) lgkmcnt(4)
    v_mfma_f32_32x32x16_bf16 v[16:31], v[228:231], v[108:111], v[16:31]
    ds_read_b64_tr_b16 v[220:221], v10 offset:16384
    ds_read_b64_tr_b16 v[222:223], v10 offset:17408
    v_mfma_f32_32x32x16_bf16 v[32:47], v[232:235], v[108:111], v[32:47]
    ds_read_b64_tr_b16 v[224:225], v11 offset:16384
    ds_read_b64_tr_b16 v[226:227], v11 offset:17408
    s_waitcnt vmcnt(7) lgkmcnt(4)
    v_mfma_f32_32x32x16_bf16 v[16:31], v[64:67], v[112:115], v[16:31]
    ds_read_b64_tr_b16 v[228:229], v10 offset:17920
    ds_read_b64_tr_b16 v[230:231], v10 offset:18944
    v_mfma_f32_32x32x16_bf16 v[32:47], v[68:71], v[112:115], v[32:47]
    ds_read_b64_tr_b16 v[232:233], v11 offset:17920
    ds_read_b64_tr_b16 v[234:235], v11 offset:18944
    s_waitcnt vmcnt(6) lgkmcnt(4)
    v_mfma_f32_32x32x16_bf16 v[16:31], v[220:223], v[116:119], v[16:31]
    ds_read_b64_tr_b16 v[64:65], v10 offset:19968
    ds_read_b64_tr_b16 v[66:67], v10 offset:20992
    v_mfma_f32_32x32x16_bf16 v[32:47], v[224:227], v[116:119], v[32:47]
    ds_read_b64_tr_b16 v[68:69], v11 offset:19968
    ds_read_b64_tr_b16 v[70:71], v11 offset:20992
    s_waitcnt vmcnt(5) lgkmcnt(4)
    v_mfma_f32_32x32x16_bf16 v[16:31], v[228:231], v[120:123], v[16:31]
    ds_read_b64_tr_b16 v[220:221], v10 offset:21504
    ds_read_b64_tr_b16 v[222:223], v10 offset:22528
    v_mfma_f32_32x32x16_bf16 v[32:47], v[232:235], v[120:123], v[32:47]
    ds_read_b64_tr_b16 v[224:225], v11 offset:21504
    ds_read_b64_tr_b16 v[226:227], v11 offset:22528
    s_waitcnt vmcnt(4) lgkmcnt(4)
    v_mfma_f32_32x32x16_bf16 v[16:31], v[64:67], v[124:127], v[16:31]
    ds_read_b64_tr_b16 v[228:229], v10 offset:23552
    ds_read_b64_tr_b16 v[230:231], v10 offset:24576
    v_mfma_f32_32x32x16_bf16 v[32:47], v[68:71], v[124:127], v[32:47]
    ds_read_b64_tr_b16 v[232:233], v11 offset:23552
    ds_read_b64_tr_b16 v[234:235], v11 offset:24576
    s_waitcnt vmcnt(3) lgkmcnt(4)
    v_mfma_f32_32x32x16_bf16 v[16:31], v[220:223], v[128:131], v[16:31]
    ds_read_b64_tr_b16 v[64:65], v10 offset:25088
    ds_read_b64_tr_b16 v[66:67], v10 offset:26112
    v_mfma_f32_32x32x16_bf16 v[32:47], v[224:227], v[128:131], v[32:47]
    ds_read_b64_tr_b16 v[68:69], v11 offset:25088
    ds_read_b64_tr_b16 v[70:71], v11 offset:26112
    s_waitcnt vmcnt(2) lgkmcnt(4)
    v_mfma_f32_32x32x16_bf16 v[16:31], v[228:231], v[132:135], v[16:31]
    ds_read_b64_tr_b16 v[220:221], v10 offset:27136
    ds_read_b64_tr_b16 v[222:223], v10 offset:28160
    v_mfma_f32_32x32x16_bf16 v[32:47], v[232:235], v[132:135], v[32:47]
    ds_read_b64_tr_b16 v[224:225], v11 offset:27136
    ds_read_b64_tr_b16 v[226:227], v11 offset:28160
    s_waitcnt vmcnt(1) lgkmcnt(4)
    v_mfma_f32_32x32x16_bf16 v[16:31], v[64:67], v[136:139], v[16:31]
    v_mfma_f32_32x32x16_bf16 v[32:47], v[68:71], v[136:139], v[32:47]
    s_waitcnt vmcnt(0) lgkmcnt(0)
    v_mfma_f32_32x32x16_bf16 v[16:31], v[220:223], v[140:143], v[16:31]
    v_mfma_f32_32x32x16_bf16 v[32:47], v[224:227], v[140:143], v[32:47]
    s_lshl_b32 s46, s3, 12
    s_xor_b32 s47, s3, 2
    s_lshl_b32 s47, s47, 12
    s_add_u32 s46, s46, 58368
    s_add_u32 s47, s47, 58368
    v_add_u32 v6, s46, v3
    v_add_u32 v7, s47, v3
    s_nop 4
    s_cmp_lg_u32 s43, 0
    s_cbranch_scc1 L_h1_32
    ds_write_b128 v6, v[32:35] offset:0
    ds_write_b128 v6, v[36:39] offset:1024
    ds_write_b128 v6, v[40:43] offset:2048
    ds_write_b128 v6, v[44:47] offset:3072
    s_branch L_hj_33
L_h1_32:
    ds_write_b128 v6, v[16:19] offset:0
    ds_write_b128 v6, v[20:23] offset:1024
    ds_write_b128 v6, v[24:27] offset:2048
    ds_write_b128 v6, v[28:31] offset:3072
    s_nop 1
    v_pk_mov_b32 v[16:17], v[32:33], v[32:33] op_sel:[0,1]
    v_pk_mov_b32 v[18:19], v[34:35], v[34:35] op_sel:[0,1]
    v_pk_mov_b32 v[20:21], v[36:37], v[36:37] op_sel:[0,1]
    v_pk_mov_b32 v[22:23], v[38:39], v[38:39] op_sel:[0,1]
    v_pk_mov_b32 v[24:25], v[40:41], v[40:41] op_sel:[0,1]
    v_pk_mov_b32 v[26:27], v[42:43], v[42:43] op_sel:[0,1]
    v_pk_mov_b32 v[28:29], v[44:45], v[44:45] op_sel:[0,1]
    v_pk_mov_b32 v[30:31], v[46:47], v[46:47] op_sel:[0,1]
L_hj_33:
    v_lshlrev_b32 v8, 16, v240
    v_and_b32 v9, 0xffff0000, v240
    v_pk_add_f32 v[16:17], v[16:17], v[8:9]
    v_lshlrev_b32 v8, 16, v241
    v_and_b32 v9, 0xffff0000, v241
    v_pk_add_f32 v[18:19], v[18:19], v[8:9]
    v_lshlrev_b32 v8, 16, v242
    v_and_b32 v9, 0xffff0000, v242
    v_pk_add_f32 v[20:21], v[20:21], v[8:9]
    v_lshlrev_b32 v8, 16, v243
    v_and_b32 v9, 0xffff0000, v243
    v_pk_add_f32 v[22:23], v[22:23], v[8:9]
    v_lshlrev_b32 v8, 16, v244
    v_and_b32 v9, 0xffff0000, v244
    v_pk_add_f32 v[24:25], v[24:25], v[8:9]
    v_lshlrev_b32 v8, 16, v245
    v_and_b32 v9, 0xffff0000, v245
    v_pk_add_f32 v[26:27], v[26:27], v[8:9]
    v_lshlrev_b32 v8, 16, v246
    v_and_b32 v9, 0xffff0000, v246
    v_pk_add_f32 v[28:29], v[28:29], v[8:9]
    v_lshlrev_b32 v8, 16, v247
    v_and_b32 v9, 0xffff0000, v247
    v_pk_add_f32 v[30:31], v[30:31], v[8:9]
    s_waitcnt lgkmcnt(0)
    s_barrier
    ds_read_b128 v[48:51], v7 offset:0
    ds_read_b128 v[52:55], v7 offset:1024
    ds_read_b128 v[56:59], v7 offset:2048
    ds_read_b128 v[60:63], v7 offset:3072
    s_waitcnt lgkmcnt(3)
    v_pk_add_f32 v[16:17], v[16:17], v[48:49]
    v_pk_add_f32 v[18:19], v[18:19], v[50:51]
    s_waitcnt lgkmcnt(2)
    v_pk_add_f32 v[20:21], v[20:21], v[52:53]
    v_pk_add_f32 v[22:23], v[22:23], v[54:55]
    s_waitcnt lgkmcnt(1)
    v_pk_add_f32 v[24:25], v[24:25], v[56:57]
    v_pk_add_f32 v[26:27], v[26:27], v[58:59]
    s_waitcnt lgkmcnt(0)
    v_pk_add_f32 v[28:29], v[28:29], v[60:61]
    v_pk_add_f32 v[30:31], v[30:31], v[62:63]
    v_cvt_pk_bf16_f32 v240, v16, v17
    v_cvt_pk_bf16_f32 v241, v18, v19
    v_cvt_pk_bf16_f32 v242, v20, v21
    v_cvt_pk_bf16_f32 v243, v22, v23
    v_cvt_pk_bf16_f32 v244, v24, v25
    v_cvt_pk_bf16_f32 v245, v26, v27
    v_cvt_pk_bf16_f32 v246, v28, v29
    v_cvt_pk_bf16_f32 v247, v30, v31
    s_mul_i32 s46, s44, 28672
    s_lshl_b32 s47, s45, 11
    s_add_u32 s46, s46, s47
    s_add_u32 s46, s46, 7602176
    buffer_store_dwordx4 v[240:243], v3, s[24:27], s46 offen sc1
    buffer_store_dwordx4 v[244:247], v3, s[24:27], s46 offen offset:1024 sc1
    v_lshlrev_b32 v16, 16, v240
    v_and_b32 v17, 0xffff0000, v240
    v_lshlrev_b32 v18, 16, v241
    v_and_b32 v19, 0xffff0000, v241
    v_lshlrev_b32 v20, 16, v242
    v_and_b32 v21, 0xffff0000, v242
    v_lshlrev_b32 v22, 16, v243
    v_and_b32 v23, 0xffff0000, v243
    v_lshlrev_b32 v24, 16, v244
    v_and_b32 v25, 0xffff0000, v244
    v_lshlrev_b32 v26, 16, v245
    v_and_b32 v27, 0xffff0000, v245
    v_lshlrev_b32 v28, 16, v246
    v_and_b32 v29, 0xffff0000, v246
    v_lshlrev_b32 v30, 16, v247
    v_and_b32 v31, 0xffff0000, v247
    v_pk_add_f32 v[6:7], v[16:17], v[18:19]
    v_pk_mul_f32 v[8:9], v[16:17], v[16:17]
    v_pk_fma_f32 v[8:9], v[18:19], v[18:19], v[8:9]
    v_pk_add_f32 v[6:7], v[6:7], v[20:21]
    v_pk_fma_f32 v[8:9], v[20:21], v[20:21], v[8:9]
    v_pk_add_f32 v[6:7], v[6:7], v[22:23]
    v_pk_fma_f32 v[8:9], v[22:23], v[22:23], v[8:9]
    v_pk_add_f32 v[6:7], v[6:7], v[24:25]
    v_pk_fma_f32 v[8:9], v[24:25], v[24:25], v[8:9]
    v_pk_add_f32 v[6:7], v[6:7], v[26:27]
    v_pk_fma_f32 v[8:9], v[26:27], v[26:27], v[8:9]
    v_pk_add_f32 v[6:7], v[6:7], v[28:29]
    v_pk_fma_f32 v[8:9], v[28:29], v[28:29], v[8:9]
    v_pk_add_f32 v[6:7], v[6:7], v[30:31]
    v_pk_fma_f32 v[8:9], v[30:31], v[30:31], v[8:9]
    v_add_f32 v6, v6, v7
    v_add_f32 v7, v8, v9
    s_mul_i32 s46, s44, 14
    s_add_u32 s46, s46, s45
    v_permlane32_swap_b32 v6, v7
    s_lshl_b32 s46, s46, 8
    s_add_u32 s46, s46, 9437184
    v_add_f32 v6, v6, v7
    v_lshlrev_b32 v5, 2, v0
    buffer_store_dword v6, v5, s[24:27], s46 offen sc1
L_C3E:
    v_bfe_u32 v5, v0, 2, 2
    v_mul_u32_u24 v6, 8, v1
    v_add_u32 v6, v6, v5
    v_lshlrev_b32 v6, 7, v6
    v_and_b32 v7, 1, v0
    v_lshlrev_b32 v7, 5, v7
    v_bfe_u32 v8, v0, 4, 1
    v_lshl_add_u32 v7, v8, 4, v7
    v_bfe_u32 v8, v0, 1, 1
    v_lshl_add_u32 v7, v8, 3, v7
    v_lshrrev_b32 v5, 1, v5
    v_lshl_add_u32 v7, v5, 6, v7
    v_add_u32 v248, v6, v7
    v_xor_b32 v249, 64, v248
    s_lshl_b32 s46, s43, 13
    v_add_u32 v248, s46, v248
    v_add_u32 v249, s46, v249
    v_add_u32 v250, 0x10000, v248
    v_add_u32 v251, 0x10000, v249
    v_add_u32 v252, 0x20000, v248
    v_add_u32 v253, 0x20000, v249
    s_lshl_b32 s54, s3, 10
    s_add_u32 s54, s54, 151552
    v_add_u32 v254, s54, v3
    s_mul_i32 s54, s44, 114688
    s_mul_i32 s55, s43, 57344
    s_add_u32 s54, s54, s55
    s_add_u32 s54, s54, 9699328
    s_mov_b32 s28, s18
    s_mov_b32 s29, s19
    s_mov_b32 s30, 1835008
    s_mov_b32 s31, 0x20000
    s_lshl_b32 s46, s36, 1
    s_and_b32 s47, s37, 1
    s_add_u32 s46, s46, s47
    s_lshr_b32 s47, s37, 1
    s_lshl_b32 s48, s46, 2
    s_add_u32 s48, s48, s3
    s_mul_i32 s49, s48, 28672
    s_add_u32 s49, s49, 7602176
    s_mul_i32 s50, s48, 3584
    s_add_u32 s50, s50, 9437184
    v_add_u32 v10, 0x10000, v3
    v_add_u32 v11, 0x20000, v3
    v_lshlrev_b32 v12, 2, v0
    s_and_b32 s51, s37, 1
    s_lshl_b32 s51, s51, 1
    v_and_b32 v4, 1, v0
    v_add_u32 v4, s51, v4
    v_bfe_u32 v5, v0, 1, 3
    v_min_u32 v5, 6, v5
    v_lshl_add_u32 v4, v5, 2, v4
    v_lshl_add_u32 v4, v4, 3, s36
    v_lshlrev_b32 v4, 7, v4
    s_waitcnt vmcnt(0) lgkmcnt(0)
    s_barrier
    s_cmp_lg_u32 s3, 1
    s_cbranch_scc1 L_g_35
    s_lshl_b32 s58, s2, 7
    s_add_u32 s58, s58, 20447232
    v_mov_b32 v5, 3
    s_mov_b64 exec, 1
    buffer_store_dword v5, off, s[24:27], s58 sc1
    s_mov_b64 exec, -1
L_g_35:
    s_cmp_lg_u32 s3, 0
    s_cbranch_scc1 L_n1_34
    s_lshl_b32 s58, s2, 7
    s_add_u32 s57, s58, 20480000
    s_add_u32 s98, s97, 3
    v_mov_b32 v6, s98
    s_mov_b64 exec, 1
    buffer_store_dword v6, off, s[24:27], s57
    s_mov_b64 exec, -1
    s_mov_b32 s58, 0x40000
    s_mov_b32 s99, 20480000
    s_mov_b32 s57, 20447232
    s_add_u32 s98, s97, 3
L_lp_36:
    s_mov_b32 s59, 8
L_lf_37:
    buffer_load_dword v5, v4, s[24:27], s99 offen sc1
    s_sub_u32 s59, s59, 1
    s_waitcnt vmcnt(0)
    v_subrev_u32 v5, s98, v5
    v_cmp_le_u32 vcc, 4, v5
    s_cmp_lg_u32 s59, 0
    s_cbranch_vccz L_dn_38
    s_cbranch_scc1 L_lf_37
    buffer_load_dword v5, v4, s[24:27], s57 offen sc1
    s_sub_u32 s58, s58, 1
    s_waitcnt vmcnt(0)
    v_cmp_gt_u32 vcc, 3, v5
    s_cmp_lg_u32 s58, 0
    s_cbranch_vccz L_dn_38
    s_cbranch_scc1 L_lp_36
L_dn_38:
L_n1_34:
    s_barrier
    s_add_u32 s51, s49, 0
    buffer_load_dwordx4 v[96:99], v3, s[24:27], s51 offen offset:0 sc1
    buffer_load_dwordx4 v[100:103], v3, s[24:27], s51 offen offset:1024 sc1
    ds_read_b128 v[212:215], v10 offset:12288
    ds_read_b128 v[216:219], v10 offset:13312
    ds_read_b128 v[220:223], v10 offset:14336
    ds_read_b128 v[224:227], v10 offset:15360
    ds_read_b128 v[228:231], v10 offset:16384
    ds_read_b128 v[232:235], v10 offset:17408
    buffer_load_dwordx4 v[104:107], v3, s[24:27], s51 offen offset:2048 sc1
    buffer_load_dwordx4 v[108:111], v3, s[24:27], s51 offen offset:3072 sc1
    s_add_u32 s51, s49, 4096
    buffer_load_dwordx4 v[112:115], v3, s[24:27], s51 offen offset:0 sc1
    buffer_load_dwordx4 v[116:119], v3, s[24:27], s51 offen offset:1024 sc1
    buffer_load_dwordx4 v[120:123], v3, s[24:27], s51 offen offset:2048 sc1
    buffer_load_dwordx4 v[124:127], v3, s[24:27], s51 offen offset:3072 sc1
    s_add_u32 s51, s49, 8192
    buffer_load_dwordx4 v[128:131], v3, s[24:27], s51 offen offset:0 sc1
    buffer_load_dwordx4 v[132:135], v3, s[24:27], s51 offen offset:1024 sc1
    s_mul_i32 s52, s48, 112
    s_mul_i32 s53, s47, 7
    s_add_u32 s52, s52, s53
    s_lshl_b32 s52, s52, 10
    s_add_u32 s52, s52, 9699328
    s_add_u32 s53, s52, 4096
    s_waitcnt vmcnt(9)
    s_waitcnt lgkmcnt(5)
    v_mfma_f32_32x32x16_bf16 v[16:31], v[212:215], v[96:99], 0
    ds_read_b128 v[236:239], v10 offset:18432
    buffer_load_dwordx4 v[136:139], v3, s[24:27], s51 offen offset:2048 sc1
    s_waitcnt lgkmcnt(5)
    v_mfma_f32_32x32x16_bf16 v[32:47], v[216:219], v[96:99], 0
    ds_read_b128 v[212:215], v10 offset:19456
    buffer_load_dwordx4 v[140:143], v3, s[24:27], s51 offen offset:3072 sc1
    s_waitcnt lgkmcnt(5)
    v_mfma_f32_32x32x16_bf16 v[48:63], v[220:223], v[96:99], 0
    ds_read_b128 v[216:219], v10 offset:20480
    s_waitcnt vmcnt(10)
    s_waitcnt lgkmcnt(5)
    v_mfma_f32_32x32x16_bf16 v[16:31], v[224:227], v[100:103], v[16:31]
    ds_read_b128 v[220:223], v10 offset:21504
    s_add_u32 s51, s49, 12288
    buffer_load_dwordx4 v[144:147], v3, s[24:27], s51 offen offset:0 sc1
    s_waitcnt lgkmcnt(5)
    v_mfma_f32_32x32x16_bf16 v[32:47], v[228:231], v[100:103], v[32:47]
    ds_read_b128 v[224:227], v10 offset:22528
    buffer_load_dwordx4 v[148:151], v3, s[24:27], s51 offen offset:1024 sc1
    s_waitcnt lgkmcnt(5)
    v_mfma_f32_32x32x16_bf16 v[48:63], v[232:235], v[100:103], v[48:63]
    ds_read_b128 v[228:231], v10 offset:23552
    s_waitcnt vmcnt(11)
    s_waitcnt lgkmcnt(5)
    v_mfma_f32_32x32x16_bf16 v[16:31], v[236:239], v[104:107], v[16:31]
    ds_read_b128 v[232:235], v10 offset:24576
    buffer_load_dwordx4 v[152:155], v3, s[24:27], s51 offen offset:2048 sc1
    s_waitcnt lgkmcnt(5)
    v_mfma_f32_32x32x16_bf16 v[32:47], v[212:215], v[104:107], v[32:47]
    ds_read_b128 v[236:239], v10 offset:25600
    buffer_load_dwordx4 v[156:159], v3, s[24:27], s51 offen offset:3072 sc1
    s_waitcnt lgkmcnt(5)
    v_mfma_f32_32x32x16_bf16 v[48:63], v[216:219], v[104:107], v[48:63]
    ds_read_b128 v[212:215], v10 offset:26624
    s_waitcnt vmcnt(12)
    s_waitcnt lgkmcnt(5)
    v_mfma_f32_32x32x16_bf16 v[16:31], v[220:223], v[108:111], v[16:31]
    ds_read_b128 v[216:219], v10 offset:27648
    s_add_u32 s51, s49, 16384
    buffer_load_dwordx4 v[160:163], v3, s[24:27], s51 offen offset:0 sc1
    s_waitcnt lgkmcnt(5)
    v_mfma_f32_32x32x16_bf16 v[32:47], v[224:227], v[108:111], v[32:47]
    ds_read_b128 v[220:223], v10 offset:28672
    buffer_load_dwordx4 v[164:167], v3, s[24:27], s51 offen offset:1024 sc1
    s_waitcnt lgkmcnt(5)
    v_mfma_f32_32x32x16_bf16 v[48:63], v[228:231], v[108:111], v[48:63]
    ds_read_b128 v[224:227], v10 offset:29696
    s_waitcnt vmcnt(13)
    s_waitcnt lgkmcnt(5)
    v_mfma_f32_32x32x16_bf16 v[16:31], v[232:235], v[112:115], v[16:31]
    ds_read_b128 v[228:231], v10 offset:30720
    buffer_load_dwordx4 v[168:171], v3, s[24:27], s51 offen offset:2048 sc1
    s_waitcnt lgkmcnt(5)
    v_mfma_f32_32x32x16_bf16 v[32:47], v[236:239], v[112:115], v[32:47]
    ds_read_b128 v[232:235], v10 offset:31744
    buffer_load_dwordx4 v[172:175], v3, s[24:27], s51 offen offset:3072 sc1
    s_waitcnt lgkmcnt(5)
    v_mfma_f32_32x32x16_bf16 v[48:63], v[212:215], v[112:115], v[48:63]
    ds_read_b128 v[236:239], v10 offset:32768
    s_waitcnt vmcnt(14)
    s_waitcnt lgkmcnt(5)
    v_mfma_f32_32x32x16_bf16 v[16:31], v[216:219], v[116:119], v[16:31]
    ds_read_b128 v[212:215], v10 offset:33792
    s_add_u32 s51, s49, 20480
    buffer_load_dwordx4 v[176:179], v3, s[24:27], s51 offen offset:0 sc1
    s_waitcnt lgkmcnt(5)
    v_mfma_f32_32x32x16_bf16 v[32:47], v[220:223], v[116:119], v[32:47]
    ds_read_b128 v[216:219], v10 offset:34816
    buffer_load_dwordx4 v[180:183], v3, s[24:27], s51 offen offset:1024 sc1
    s_waitcnt lgkmcnt(5)
    v_mfma_f32_32x32x16_bf16 v[48:63], v[224:227], v[116:119], v[48:63]
    ds_read_b128 v[220:223], v10 offset:35840
    s_waitcnt vmcnt(15)
    s_waitcnt lgkmcnt(5)
    v_mfma_f32_32x32x16_bf16 v[16:31], v[228:231], v[120:123], v[16:31]
    ds_read_b128 v[224:227], v10 offset:36864
    buffer_load_dwordx4 v[184:187], v3, s[24:27], s51 offen offset:2048 sc1
    s_waitcnt lgkmcnt(5)
    v_mfma_f32_32x32x16_bf16 v[32:47], v[232:235], v[120:123], v[32:47]
    ds_read_b128 v[228:231], v10 offset:37888
    buffer_load_dwordx4 v[188:191], v3, s[24:27], s51 offen offset:3072 sc1
    s_waitcnt lgkmcnt(5)
    v_mfma_f32_32x32x16_bf16 v[48:63], v[236:239], v[120:123], v[48:63]
    ds_read_b128 v[232:235], v10 offset:38912
    s_waitcnt vmcnt(16)
    s_waitcnt lgkmcnt(5)
    v_mfma_f32_32x32x16_bf16 v[16:31], v[212:215], v[124:127], v[16:31]
    ds_read_b128 v[236:239], v10 offset:39936
    s_add_u32 s51, s49, 24576
    buffer_load_dwordx4 v[192:195], v3, s[24:27], s51 offen offset:0 sc1
    s_barrier
    s_waitcnt lgkmcnt(5)
    v_mfma_f32_32x32x16_bf16 v[32:47], v[216:219], v[124:127], v[32:47]
    ds_read_b128 v[212:215], v10 offset:40960
    buffer_load_dwordx4 v[196:199], v3, s[24:27], s51 offen offset:1024 sc1
    s_waitcnt lgkmcnt(5)
    v_mfma_f32_32x32x16_bf16 v[48:63], v[220:223], v[124:127], v[48:63]
    ds_read_b128 v[216:219], v10 offset:41984
    s_waitcnt vmcnt(17)
    s_waitcnt lgkmcnt(5)
    v_mfma_f32_32x32x16_bf16 v[16:31], v[224:227], v[128:131], v[16:31]
    ds_read_b128 v[220:223], v10 offset:43008
    buffer_load_dwordx4 v[200:203], v3, s[24:27], s51 offen offset:2048 sc1
    s_waitcnt lgkmcnt(5)
    v_mfma_f32_32x32x16_bf16 v[32:47], v[228:231], v[128:131], v[32:47]
    ds_read_b128 v[224:227], v10 offset:44032
    buffer_load_dwordx4 v[204:207], v3, s[24:27], s51 offen offset:3072 sc1
    s_waitcnt lgkmcnt(5)
    v_mfma_f32_32x32x16_bf16 v[48:63], v[232:235], v[128:131], v[48:63]
    ds_read_b128 v[228:231], v10 offset:45056
    s_waitcnt vmcnt(18)
    s_waitcnt lgkmcnt(5)
    v_mfma_f32_32x32x16_bf16 v[16:31], v[236:239], v[132:135], v[16:31]
    ds_read_b128 v[232:235], v10 offset:46080
    buffer_load_dword v64, v12, s[24:27], s50 offen offset:0 sc1
    s_waitcnt lgkmcnt(5)
    v_mfma_f32_32x32x16_bf16 v[32:47], v[212:215], v[132:135], v[32:47]
    ds_read_b128 v[236:239], v10 offset:47104
    buffer_load_dword v65, v12, s[24:27], s50 offen offset:256 sc1
    s_waitcnt lgkmcnt(5)
    v_mfma_f32_32x32x16_bf16 v[48:63], v[216:219], v[132:135], v[48:63]
    ds_read_b128 v[212:215], v10 offset:48128
    s_waitcnt vmcnt(19)
    s_waitcnt lgkmcnt(5)
    v_mfma_f32_32x32x16_bf16 v[16:31], v[220:223], v[136:139], v[16:31]
    ds_read_b128 v[216:219], v10 offset:49152
    buffer_load_dword v66, v12, s[24:27], s50 offen offset:512 sc1
    s_waitcnt lgkmcnt(5)
    v_mfma_f32_32x32x16_bf16 v[32:47], v[224:227], v[136:139], v[32:47]
    ds_read_b128 v[220:223], v10 offset:50176
    buffer_load_dword v67, v12, s[24:27], s50 offen offset:768 sc1
    s_waitcnt lgkmcnt(5)
    v_mfma_f32_32x32x16_bf16 v[48:63], v[228:231], v[136:139], v[48:63]
    ds_read_b128 v[224:227], v10 offset:51200
    s_waitcnt vmcnt(20)
    s_waitcnt lgkmcnt(5)
    v_mfma_f32_32x32x16_bf16 v[16:31], v[232:235], v[140:143], v[16:31]
    ds_read_b128 v[228:231], v10 offset:52224
    buffer_load_dword v68, v12, s[24:27], s50 offen offset:1024 sc1
    s_waitcnt lgkmcnt(5)
    v_mfma_f32_32x32x16_bf16 v[32:47], v[236:239], v[140:143], v[32:47]
    ds_read_b128 v[232:235], v10 offset:53248
    buffer_load_dword v69, v12, s[24:27], s50 offen offset:1280 sc1
    s_waitcnt lgkmcnt(5)
    v_mfma_f32_32x32x16_bf16 v[48:63], v[212:215], v[140:143], v[48:63]
    ds_read_b128 v[236:239], v10 offset:54272
    s_waitcnt vmcnt(21)
    s_waitcnt lgkmcnt(5)
    v_mfma_f32_32x32x16_bf16 v[16:31], v[216:219], v[144:147], v[16:31]
    ds_read_b128 v[212:215], v10 offset:55296
    buffer_load_dword v70, v12, s[24:27], s50 offen offset:1536 sc1
    s_waitcnt lgkmcnt(5)
    v_mfma_f32_32x32x16_bf16 v[32:47], v[220:223], v[144:147], v[32:47]
    ds_read_b128 v[216:219], v10 offset:56320
    buffer_load_dword v71, v12, s[24:27], s50 offen offset:1792 sc1
    s_waitcnt lgkmcnt(5)
    v_mfma_f32_32x32x16_bf16 v[48:63], v[224:227], v[144:147], v[48:63]
    ds_read_b128 v[220:223], v10 offset:57344
    s_waitcnt vmcnt(22)
    s_waitcnt lgkmcnt(5)
    v_mfma_f32_32x32x16_bf16 v[16:31], v[228:231], v[148:151], v[16:31]
    ds_read_b128 v[224:227], v10 offset:58368
    buffer_load_dword v72, v12, s[24:27], s50 offen offset:2048 sc1
    s_waitcnt lgkmcnt(5)
    v_mfma_f32_32x32x16_bf16 v[32:47], v[232:235], v[148:151], v[32:47]
    ds_read_b128 v[228:231], v10 offset:59392
    buffer_load_dword v73, v12, s[24:27], s50 offen offset:2304 sc1
    s_waitcnt lgkmcnt(5)
    v_mfma_f32_32x32x16_bf16 v[48:63], v[236:239], v[148:151], v[48:63]
    ds_read_b128 v[232:235], v10 offset:60416
    s_waitcnt vmcnt(23)
    s_waitcnt lgkmcnt(5)
    v_mfma_f32_32x32x16_bf16 v[16:31], v[212:215], v[152:155], v[16:31]
    ds_read_b128 v[236:239], v10 offset:61440
    buffer_load_dword v74, v12, s[24:27], s50 offen offset:2560 sc1
    s_waitcnt lgkmcnt(5)
    v_mfma_f32_32x32x16_bf16 v[32:47], v[216:219], v[152:155], v[32:47]
    ds_read_b128 v[212:215], v10 offset:62464
    buffer_load_dword v75, v12, s[24:27], s50 offen offset:2816 sc1
    s_waitcnt lgkmcnt(5)
    v_mfma_f32_32x32x16_bf16 v[48:63], v[220:223], v[152:155], v[48:63]
    ds_read_b128 v[216:219], v10 offset:63488
    s_waitcnt vmcnt(24)
    s_waitcnt lgkmcnt(5)
    v_mfma_f32_32x32x16_bf16 v[16:31], v[224:227], v[156:159], v[16:31]
    ds_read_b128 v[220:223], v10 offset:64512
    buffer_load_dword v76, v12, s[24:27], s50 offen offset:3072 sc1
    s_waitcnt lgkmcnt(5)
    v_mfma_f32_32x32x16_bf16 v[32:47], v[228:231], v[156:159], v[32:47]
    ds_read_b128 v[224:227], v11 offset:0
    buffer_load_dword v77, v12, s[24:27], s50 offen offset:3328 sc1
    s_waitcnt lgkmcnt(5)
    v_mfma_f32_32x32x16_bf16 v[48:63], v[232:235], v[156:159], v[48:63]
    ds_read_b128 v[228:231], v11 offset:1024
    s_waitcnt vmcnt(25)
    s_waitcnt lgkmcnt(5)
    v_mfma_f32_32x32x16_bf16 v[16:31], v[236:239], v[160:163], v[16:31]
    ds_read_b128 v[232:235], v11 offset:2048
    s_waitcnt lgkmcnt(5)
    v_mfma_f32_32x32x16_bf16 v[32:47], v[212:215], v[160:163], v[32:47]
    ds_read_b128 v[236:239], v11 offset:3072
    s_barrier
    s_waitcnt lgkmcnt(5)
    v_mfma_f32_32x32x16_bf16 v[48:63], v[216:219], v[160:163], v[48:63]
    ds_read_b128 v[212:215], v11 offset:4096
    s_waitcnt vmcnt(24)
    s_waitcnt lgkmcnt(5)
    v_mfma_f32_32x32x16_bf16 v[16:31], v[220:223], v[164:167], v[16:31]
    ds_read_b128 v[216:219], v11 offset:5120
    s_waitcnt lgkmcnt(5)
    v_mfma_f32_32x32x16_bf16 v[32:47], v[224:227], v[164:167], v[32:47]
    ds_read_b128 v[220:223], v11 offset:6144
    s_waitcnt lgkmcnt(5)
    v_mfma_f32_32x32x16_bf16 v[48:63], v[228:231], v[164:167], v[48:63]
    ds_read_b128 v[224:227], v11 offset:7168
    s_waitcnt vmcnt(23)
    s_waitcnt lgkmcnt(5)
    v_mfma_f32_32x32x16_bf16 v[16:31], v[232:235], v[168:171], v[16:31]
    ds_read_b128 v[228:231], v11 offset:8192
    s_waitcnt lgkmcnt(5)
    v_mfma_f32_32x32x16_bf16 v[32:47], v[236:239], v[168:171], v[32:47]
    ds_read_b128 v[232:235], v11 offset:9216
    s_waitcnt lgkmcnt(5)
    v_mfma_f32_32x32x16_bf16 v[48:63], v[212:215], v[168:171], v[48:63]
    ds_read_b128 v[236:239], v11 offset:10240
    s_waitcnt vmcnt(22)
    s_waitcnt lgkmcnt(5)
    v_mfma_f32_32x32x16_bf16 v[16:31], v[216:219], v[172:175], v[16:31]
    ds_read_b128 v[212:215], v11 offset:11264
    s_waitcnt lgkmcnt(5)
    v_mfma_f32_32x32x16_bf16 v[32:47], v[220:223], v[172:175], v[32:47]
    ds_read_b128 v[216:219], v11 offset:12288
    s_waitcnt lgkmcnt(5)
    v_mfma_f32_32x32x16_bf16 v[48:63], v[224:227], v[172:175], v[48:63]
    ds_read_b128 v[220:223], v11 offset:13312
    s_waitcnt vmcnt(21)
    s_waitcnt lgkmcnt(5)
    v_mfma_f32_32x32x16_bf16 v[16:31], v[228:231], v[176:179], v[16:31]
    ds_read_b128 v[224:227], v11 offset:14336
    s_waitcnt lgkmcnt(5)
    v_mfma_f32_32x32x16_bf16 v[32:47], v[232:235], v[176:179], v[32:47]
    ds_read_b128 v[228:231], v11 offset:15360
    s_waitcnt lgkmcnt(5)
    v_mfma_f32_32x32x16_bf16 v[48:63], v[236:239], v[176:179], v[48:63]
    ds_read_b128 v[232:235], v11 offset:16384
    s_waitcnt vmcnt(20)
    s_waitcnt lgkmcnt(5)
    v_mfma_f32_32x32x16_bf16 v[16:31], v[212:215], v[180:183], v[16:31]
    ds_read_b128 v[236:239], v11 offset:17408
    s_waitcnt lgkmcnt(5)
    v_mfma_f32_32x32x16_bf16 v[32:47], v[216:219], v[180:183], v[32:47]
    ds_read_b128 v[212:215], v11 offset:18432
    s_waitcnt lgkmcnt(5)
    v_mfma_f32_32x32x16_bf16 v[48:63], v[220:223], v[180:183], v[48:63]
    ds_read_b128 v[216:219], v11 offset:19456
    s_waitcnt vmcnt(19)
    s_waitcnt lgkmcnt(5)
    v_mfma_f32_32x32x16_bf16 v[16:31], v[224:227], v[184:187], v[16:31]
    ds_read_b128 v[220:223], v11 offset:20480
    s_waitcnt vmcnt(0)
    v_add_f32 v6, v64, v65
    s_waitcnt lgkmcnt(5)
    v_mfma_f32_32x32x16_bf16 v[32:47], v[228:231], v[184:187], v[32:47]
    ds_read_b128 v[224:227], v11 offset:21504
    v_add_f32 v6, v6, v66
    v_add_f32 v6, v6, v67
    s_waitcnt lgkmcnt(5)
    v_mfma_f32_32x32x16_bf16 v[48:63], v[232:235], v[184:187], v[48:63]
    ds_read_b128 v[228:231], v11 offset:22528
    v_add_f32 v6, v6, v68
    v_add_f32 v6, v6, v69
    s_waitcnt vmcnt(18)
    s_waitcnt lgkmcnt(5)
    v_mfma_f32_32x32x16_bf16 v[16:31], v[236:239], v[188:191], v[16:31]
    ds_read_b128 v[232:235], v11 offset:23552
    v_add_f32 v6, v6, v70
    v_add_f32 v6, v6, v71
    s_waitcnt lgkmcnt(5)
    v_mfma_f32_32x32x16_bf16 v[32:47], v[212:215], v[188:191], v[32:47]
    ds_read_b128 v[236:239], v11 offset:24576
    v_add_f32 v6, v6, v72
    v_add_f32 v6, v6, v73
    s_waitcnt lgkmcnt(5)
    v_mfma_f32_32x32x16_bf16 v[48:63], v[216:219], v[188:191], v[48:63]
    ds_read_b128 v[212:215], v11 offset:25600
    v_add_f32 v6, v6, v74
    v_add_f32 v6, v6, v75
    s_waitcnt vmcnt(17)
    s_waitcnt lgkmcnt(5)
    v_mfma_f32_32x32x16_bf16 v[16:31], v[220:223], v[192:195], v[16:31]
    ds_read_b128 v[216:219], v11 offset:26624
    v_add_f32 v6, v6, v76
    v_add_f32 v6, v6, v77
    s_waitcnt lgkmcnt(5)
    v_mfma_f32_32x32x16_bf16 v[32:47], v[224:227], v[192:195], v[32:47]
    ds_read_b128 v[220:223], v11 offset:27648
    v_mul_f32 v6, 991054117, v6
    v_mov_b32 v7, v6
    s_waitcnt lgkmcnt(5)
    v_mfma_f32_32x32x16_bf16 v[48:63], v[228:231], v[192:195], v[48:63]
    ds_read_b128 v[224:227], v11 offset:28672
    s_nop 1
    v_permlane32_swap_b32 v6, v7
    s_waitcnt vmcnt(16)
    s_waitcnt lgkmcnt(5)
    v_mfma_f32_32x32x16_bf16 v[16:31], v[232:235], v[196:199], v[16:31]
    ds_read_b128 v[228:231], v11 offset:29696
    s_nop 1
    v_fma_f32 v7, -v6, v6, v7
    s_waitcnt lgkmcnt(5)
    v_mfma_f32_32x32x16_bf16 v[32:47], v[236:239], v[196:199], v[32:47]
    ds_read_b128 v[232:235], v11 offset:30720
    v_max_f32 v7, 0, v7
    v_add_f32 v7, 925353388, v7
    s_waitcnt lgkmcnt(5)
    v_mfma_f32_32x32x16_bf16 v[48:63], v[212:215], v[196:199], v[48:63]
    ds_read_b128 v[236:239], v11 offset:31744
    v_rcp_f32 v8, v7
    v_cvt_pk_bf16_f32 v208, -v6, -v6
    s_barrier
    s_waitcnt vmcnt(15)
    s_waitcnt lgkmcnt(5)
    v_mfma_f32_32x32x16_bf16 v[16:31], v[216:219], v[200:203], v[16:31]
    ds_read_b128 v[212:215], v3 offset:0
    v_mov_b32 v209, v208
    v_mov_b32 v210, v208
    s_waitcnt lgkmcnt(5)
    v_mfma_f32_32x32x16_bf16 v[32:47], v[220:223], v[200:203], v[32:47]
    ds_read_b128 v[216:219], v3 offset:1024
    v_mov_b32 v211, v208
    s_waitcnt lgkmcnt(5)
    v_mfma_f32_32x32x16_bf16 v[48:63], v[224:227], v[200:203], v[48:63]
    ds_read_b128 v[220:223], v3 offset:2048
    s_waitcnt vmcnt(14)
    s_waitcnt lgkmcnt(5)
    v_mfma_f32_32x32x16_bf16 v[16:31], v[228:231], v[204:207], v[16:31]
    ds_read_b128 v[224:227], v3 offset:3072
    s_waitcnt lgkmcnt(5)
    v_mfma_f32_32x32x16_bf16 v[32:47], v[232:235], v[204:207], v[32:47]
    ds_read_b128 v[228:231], v3 offset:4096
    s_waitcnt lgkmcnt(5)
    v_mfma_f32_32x32x16_bf16 v[48:63], v[236:239], v[204:207], v[48:63]
    ds_read_b128 v[232:235], v3 offset:5120
    s_waitcnt lgkmcnt(5)
    v_mfma_f32_32x32x16_bf16 v[16:31], v[212:215], v[208:211], v[16:31]
    ds_read_b128 v[236:239], v3 offset:6144
    s_waitcnt lgkmcnt(5)
    v_mfma_f32_32x32x16_bf16 v[32:47], v[216:219], v[208:211], v[32:47]
    ds_read_b128 v[212:215], v3 offset:7168
    s_waitcnt lgkmcnt(5)
    v_mfma_f32_32x32x16_bf16 v[48:63], v[220:223], v[208:211], v[48:63]
    ds_read_b128 v[216:219], v3 offset:8192
    s_waitcnt lgkmcnt(5)
    v_mfma_f32_32x32x16_bf16 v[64:79], v[224:227], v[96:99], 0
    ds_read_b128 v[220:223], v3 offset:9216
    s_waitcnt lgkmcnt(5)
    v_mfma_f32_32x32x16_bf16 v[80:95], v[228:231], v[96:99], 0
    ds_read_b128 v[224:227], v3 offset:10240
    s_waitcnt lgkmcnt(5)
    v_mfma_f32_32x32x16_bf16 v[64:79], v[232:235], v[100:103], v[64:79]
    ds_read_b128 v[228:231], v3 offset:11264
    s_waitcnt lgkmcnt(5)
    v_mfma_f32_32x32x16_bf16 v[80:95], v[236:239], v[100:103], v[80:95]
    ds_read_b128 v[232:235], v3 offset:12288
    s_waitcnt lgkmcnt(5)
    v_mfma_f32_32x32x16_bf16 v[64:79], v[212:215], v[104:107], v[64:79]
    ds_read_b128 v[236:239], v3 offset:13312
    v_max_f32 v16, 0, v16
    v_max_f32 v17, 0, v17
    v_max_f32 v18, 0, v18
    s_waitcnt lgkmcnt(5)
    v_mfma_f32_32x32x16_bf16 v[80:95], v[216:219], v[104:107], v[80:95]
    ds_read_b128 v[212:215], v3 offset:14336
    v_max_f32 v19, 0, v19
    v_max_f32 v24, 0, v24
    v_max_f32 v25, 0, v25
    s_waitcnt lgkmcnt(5)
    v_mfma_f32_32x32x16_bf16 v[64:79], v[220:223], v[108:111], v[64:79]
    ds_read_b128 v[216:219], v3 offset:15360
    v_max_f32 v26, 0, v26
    v_max_f32 v27, 0, v27
    v_mul_f32 v20, v20, v8
    s_waitcnt lgkmcnt(5)
    v_mfma_f32_32x32x16_bf16 v[80:95], v[224:227], v[108:111], v[80:95]
    ds_read_b128 v[220:223], v3 offset:16384
    v_mul_f32 v21, v21, v8
    v_mul_f32 v22, v22, v8
    v_mul_f32 v23, v23, v8
    s_waitcnt lgkmcnt(5)
    v_mfma_f32_32x32x16_bf16 v[64:79], v[228:231], v[112:115], v[64:79]
    ds_read_b128 v[224:227], v3 offset:17408
    v_mul_f32 v28, v28, v8
    v_mul_f32 v29, v29, v8
    v_mul_f32 v30, v30, v8
    s_waitcnt lgkmcnt(5)
    v_mfma_f32_32x32x16_bf16 v[80:95], v[232:235], v[112:115], v[80:95]
    ds_read_b128 v[228:231], v3 offset:18432
    v_mul_f32 v31, v31, v8
    v_mul_f32 v16, v16, v20
    v_mul_f32 v17, v17, v21
    s_waitcnt lgkmcnt(5)
    v_mfma_f32_32x32x16_bf16 v[64:79], v[236:239], v[116:119], v[64:79]
    ds_read_b128 v[232:235], v3 offset:19456
    v_mul_f32 v18, v18, v22
    v_mul_f32 v19, v19, v23
    v_mul_f32 v24, v24, v28
    s_waitcnt lgkmcnt(5)
    v_mfma_f32_32x32x16_bf16 v[80:95], v[212:215], v[116:119], v[80:95]
    ds_read_b128 v[236:239], v3 offset:20480
    v_mul_f32 v25, v25, v29
    v_mul_f32 v26, v26, v30
    v_mul_f32 v27, v27, v31
    s_waitcnt lgkmcnt(5)
    v_mfma_f32_32x32x16_bf16 v[64:79], v[216:219], v[120:123], v[64:79]
    ds_read_b128 v[212:215], v3 offset:21504
    v_cvt_pk_bf16_f32 v20, v16, v17
    v_cvt_pk_bf16_f32 v21, v18, v19
    v_cvt_pk_bf16_f32 v22, v24, v25
    s_waitcnt lgkmcnt(5)
    v_mfma_f32_32x32x16_bf16 v[80:95], v[220:223], v[120:123], v[80:95]
    ds_read_b128 v[216:219], v3 offset:22528
    v_cvt_pk_bf16_f32 v23, v26, v27
    buffer_store_dwordx4 v[20:23], v3, s[24:27], s52 offen offset:0 sc1
    v_max_f32 v32, 0, v32
    s_waitcnt lgkmcnt(5)
    v_mfma_f32_32x32x16_bf16 v[64:79], v[224:227], v[124:127], v[64:79]
    ds_read_b128 v[220:223], v3 offset:23552
    v_max_f32 v33, 0, v33
    v_max_f32 v34, 0, v34
    v_max_f32 v35, 0, v35
    s_waitcnt lgkmcnt(5)
    v_mfma_f32_32x32x16_bf16 v[80:95], v[228:231], v[124:127], v[80:95]
    ds_read_b128 v[224:227], v3 offset:24576
    v_max_f32 v40, 0, v40
    v_max_f32 v41, 0, v41
    v_max_f32 v42, 0, v42
    s_waitcnt lgkmcnt(5)
    v_mfma_f32_32x32x16_bf16 v[64:79], v[232:235], v[128:131], v[64:79]
    ds_read_b128 v[228:231], v3 offset:25600
    v_max_f32 v43, 0, v43
    v_mul_f32 v36, v36, v8
    v_mul_f32 v37, v37, v8
    s_waitcnt lgkmcnt(5)
    v_mfma_f32_32x32x16_bf16 v[80:95], v[236:239], v[128:131], v[80:95]
    ds_read_b128 v[232:235], v3 offset:26624
    v_mul_f32 v38, v38, v8
    v_mul_f32 v39, v39, v8
    v_mul_f32 v44, v44, v8
    s_waitcnt lgkmcnt(5)
    v_mfma_f32_32x32x16_bf16 v[64:79], v[212:215], v[132:135], v[64:79]
    ds_read_b128 v[236:239], v3 offset:27648
    v_mul_f32 v45, v45, v8
    v_mul_f32 v46, v46, v8
    v_mul_f32 v47, v47, v8
    s_barrier
    s_waitcnt lgkmcnt(5)
    v_mfma_f32_32x32x16_bf16 v[80:95], v[216:219], v[132:135], v[80:95]
    ds_read_b128 v[212:215], v3 offset:28672
    v_mul_f32 v32, v32, v36
    v_mul_f32 v33, v33, v37
    v_mul_f32 v34, v34, v38
    s_waitcnt lgkmcnt(5)
    v_mfma_f32_32x32x16_bf16 v[64:79], v[220:223], v[136:139], v[64:79]
    ds_read_b128 v[216:219], v3 offset:29696
    v_mul_f32 v35, v35, v39
    v_mul_f32 v40, v40, v44
    v_mul_f32 v41, v41, v45
    s_waitcnt lgkmcnt(5)
    v_mfma_f32_32x32x16_bf16 v[80:95], v[224:227], v[136:139], v[80:95]
    ds_read_b128 v[220:223], v3 offset:30720
    v_mul_f32 v42, v42, v46
    v_mul_f32 v43, v43, v47
    v_cvt_pk_bf16_f32 v36, v32, v33
    s_waitcnt lgkmcnt(5)
    v_mfma_f32_32x32x16_bf16 v[64:79], v[228:231], v[140:143], v[64:79]
    ds_read_b128 v[224:227], v3 offset:31744
    v_cvt_pk_bf16_f32 v37, v34, v35
    v_cvt_pk_bf16_f32 v38, v40, v41
    v_cvt_pk_bf16_f32 v39, v42, v43
    s_waitcnt lgkmcnt(5)
    v_mfma_f32_32x32x16_bf16 v[80:95], v[232:235], v[140:143], v[80:95]
    ds_read_b128 v[228:231], v3 offset:32768
    buffer_store_dwordx4 v[36:39], v3, s[24:27], s52 offen offset:1024 sc1
    v_max_f32 v48, 0, v48
    v_max_f32 v49, 0, v49
    s_waitcnt lgkmcnt(5)
    v_mfma_f32_32x32x16_bf16 v[64:79], v[236:239], v[144:147], v[64:79]
    ds_read_b128 v[232:235], v3 offset:33792
    v_max_f32 v50, 0, v50
    v_max_f32 v51, 0, v51
    v_max_f32 v56, 0, v56
    s_waitcnt lgkmcnt(5)
    v_mfma_f32_32x32x16_bf16 v[80:95], v[212:215], v[144:147], v[80:95]
    ds_read_b128 v[236:239], v3 offset:34816
    v_max_f32 v57, 0, v57
    v_max_f32 v58, 0, v58
    v_max_f32 v59, 0, v59
    s_waitcnt lgkmcnt(5)
    v_mfma_f32_32x32x16_bf16 v[64:79], v[216:219], v[148:151], v[64:79]
    ds_read_b128 v[212:215], v3 offset:35840
    v_mul_f32 v52, v52, v8
    v_mul_f32 v53, v53, v8
    v_mul_f32 v54, v54, v8
    s_waitcnt lgkmcnt(5)
    v_mfma_f32_32x32x16_bf16 v[80:95], v[220:223], v[148:151], v[80:95]
    ds_read_b128 v[216:219], v3 offset:36864
    v_mul_f32 v55, v55, v8
    v_mul_f32 v60, v60, v8
    v_mul_f32 v61, v61, v8
    s_waitcnt lgkmcnt(5)
    v_mfma_f32_32x32x16_bf16 v[64:79], v[224:227], v[152:155], v[64:79]
    ds_read_b128 v[220:223], v3 offset:37888
    v_mul_f32 v62, v62, v8
    v_mul_f32 v63, v63, v8
    v_mul_f32 v48, v48, v52
    s_waitcnt lgkmcnt(5)
    v_mfma_f32_32x32x16_bf16 v[80:95], v[228:231], v[152:155], v[80:95]
    ds_read_b128 v[224:227], v3 offset:38912
    v_mul_f32 v49, v49, v53
    v_mul_f32 v50, v50, v54
    v_mul_f32 v51, v51, v55
    s_waitcnt lgkmcnt(5)
    v_mfma_f32_32x32x16_bf16 v[64:79], v[232:235], v[156:159], v[64:79]
    ds_read_b128 v[228:231], v3 offset:39936
    v_mul_f32 v56, v56, v60
    v_mul_f32 v57, v57, v61
    v_mul_f32 v58, v58, v62
    s_waitcnt lgkmcnt(5)
    v_mfma_f32_32x32x16_bf16 v[80:95], v[236:239], v[156:159], v[80:95]
    ds_read_b128 v[232:235], v3 offset:40960
    v_mul_f32 v59, v59, v63
    v_cvt_pk_bf16_f32 v52, v48, v49
    v_cvt_pk_bf16_f32 v53, v50, v51
    s_waitcnt lgkmcnt(5)
    v_mfma_f32_32x32x16_bf16 v[64:79], v[212:215], v[160:163], v[64:79]
    ds_read_b128 v[236:239], v3 offset:41984
    v_cvt_pk_bf16_f32 v54, v56, v57
    v_cvt_pk_bf16_f32 v55, v58, v59
    buffer_store_dwordx4 v[52:55], v3, s[24:27], s52 offen offset:2048 sc1
    s_waitcnt lgkmcnt(5)
    v_mfma_f32_32x32x16_bf16 v[80:95], v[216:219], v[160:163], v[80:95]
    ds_read_b128 v[212:215], v3 offset:43008
    s_waitcnt lgkmcnt(5)
    v_mfma_f32_32x32x16_bf16 v[64:79], v[220:223], v[164:167], v[64:79]
    ds_read_b128 v[216:219], v3 offset:44032
    s_waitcnt lgkmcnt(5)
    v_mfma_f32_32x32x16_bf16 v[80:95], v[224:227], v[164:167], v[80:95]
    ds_read_b128 v[220:223], v3 offset:45056
    s_waitcnt lgkmcnt(5)
    v_mfma_f32_32x32x16_bf16 v[64:79], v[228:231], v[168:171], v[64:79]
    ds_read_b128 v[224:227], v3 offset:46080
    s_waitcnt lgkmcnt(5)
    v_mfma_f32_32x32x16_bf16 v[80:95], v[232:235], v[168:171], v[80:95]
    ds_read_b128 v[228:231], v3 offset:47104
    s_waitcnt lgkmcnt(5)
    v_mfma_f32_32x32x16_bf16 v[64:79], v[236:239], v[172:175], v[64:79]
    ds_read_b128 v[232:235], v3 offset:48128
    s_waitcnt lgkmcnt(5)
    v_mfma_f32_32x32x16_bf16 v[80:95], v[212:215], v[172:175], v[80:95]
    ds_read_b128 v[236:239], v3 offset:49152
    s_waitcnt lgkmcnt(5)
    v_mfma_f32_32x32x16_bf16 v[64:79], v[216:219], v[176:179], v[64:79]
    ds_read_b128 v[212:215], v3 offset:50176
    s_waitcnt lgkmcnt(5)
    v_mfma_f32_32x32x16_bf16 v[80:95], v[220:223], v[176:179], v[80:95]
    ds_read_b128 v[216:219], v3 offset:51200
    s_waitcnt lgkmcnt(5)
    v_mfma_f32_32x32x16_bf16 v[64:79], v[224:227], v[180:183], v[64:79]
    ds_read_b128 v[220:223], v3 offset:52224
    s_waitcnt lgkmcnt(5)
    v_mfma_f32_32x32x16_bf16 v[80:95], v[228:231], v[180:183], v[80:95]
    ds_read_b128 v[224:227], v3 offset:53248
    s_waitcnt lgkmcnt(5)
    v_mfma_f32_32x32x16_bf16 v[64:79], v[232:235], v[184:187], v[64:79]
    ds_read_b128 v[228:231], v3 offset:54272
    s_waitcnt lgkmcnt(5)
    v_mfma_f32_32x32x16_bf16 v[80:95], v[236:239], v[184:187], v[80:95]
    ds_read_b128 v[232:235], v3 offset:55296
    s_waitcnt lgkmcnt(5)
    v_mfma_f32_32x32x16_bf16 v[64:79], v[212:215], v[188:191], v[64:79]
    ds_read_b128 v[236:239], v3 offset:56320
    s_barrier
    s_waitcnt lgkmcnt(5)
    v_mfma_f32_32x32x16_bf16 v[80:95], v[216:219], v[188:191], v[80:95]
    ds_read_b128 v[212:215], v10 offset:12288
    s_waitcnt lgkmcnt(5)
    v_mfma_f32_32x32x16_bf16 v[64:79], v[220:223], v[192:195], v[64:79]
    ds_read_b128 v[216:219], v10 offset:13312
    s_waitcnt lgkmcnt(5)
    v_mfma_f32_32x32x16_bf16 v[80:95], v[224:227], v[192:195], v[80:95]
    ds_read_b128 v[220:223], v10 offset:14336
    s_waitcnt lgkmcnt(5)
    v_mfma_f32_32x32x16_bf16 v[64:79], v[228:231], v[196:199], v[64:79]
    ds_read_b128 v[224:227], v10 offset:15360
    s_waitcnt lgkmcnt(5)
    v_mfma_f32_32x32x16_bf16 v[80:95], v[232:235], v[196:199], v[80:95]
    ds_read_b128 v[228:231], v10 offset:16384
    s_waitcnt lgkmcnt(5)
    v_mfma_f32_32x32x16_bf16 v[64:79], v[236:239], v[200:203], v[64:79]
    ds_read_b128 v[232:235], v10 offset:17408
    s_waitcnt lgkmcnt(5)
    v_mfma_f32_32x32x16_bf16 v[80:95], v[212:215], v[200:203], v[80:95]
    ds_read_b128 v[236:239], v10 offset:18432
    s_waitcnt lgkmcnt(5)
    v_mfma_f32_32x32x16_bf16 v[64:79], v[216:219], v[204:207], v[64:79]
    ds_read_b128 v[212:215], v10 offset:19456
    s_waitcnt lgkmcnt(5)
    v_mfma_f32_32x32x16_bf16 v[80:95], v[220:223], v[204:207], v[80:95]
    ds_read_b128 v[216:219], v10 offset:20480
    s_waitcnt lgkmcnt(5)
    v_mfma_f32_32x32x16_bf16 v[64:79], v[224:227], v[208:211], v[64:79]
    ds_read_b128 v[220:223], v10 offset:21504
    s_waitcnt lgkmcnt(5)
    v_mfma_f32_32x32x16_bf16 v[80:95], v[228:231], v[208:211], v[80:95]
    ds_read_b128 v[224:227], v10 offset:22528
    s_waitcnt lgkmcnt(5)
    v_mfma_f32_32x32x16_bf16 v[16:31], v[232:235], v[96:99], 0
    ds_read_b128 v[228:231], v10 offset:23552
    s_waitcnt lgkmcnt(5)
    v_mfma_f32_32x32x16_bf16 v[16:31], v[236:239], v[100:103], v[16:31]
    ds_read_b128 v[232:235], v10 offset:24576
    s_waitcnt lgkmcnt(5)
    v_mfma_f32_32x32x16_bf16 v[16:31], v[212:215], v[104:107], v[16:31]
    ds_read_b128 v[236:239], v10 offset:25600
    s_waitcnt lgkmcnt(5)
    v_mfma_f32_32x32x16_bf16 v[16:31], v[216:219], v[108:111], v[16:31]
    ds_read_b128 v[212:215], v10 offset:26624
    s_waitcnt lgkmcnt(5)
    v_mfma_f32_32x32x16_bf16 v[16:31], v[220:223], v[112:115], v[16:31]
    ds_read_b128 v[216:219], v10 offset:27648
    v_max_f32 v64, 0, v64
    v_max_f32 v65, 0, v65
    v_max_f32 v66, 0, v66
    s_waitcnt vmcnt(0)
    s_barrier
    s_waitcnt lgkmcnt(5)
    v_mfma_f32_32x32x16_bf16 v[16:31], v[224:227], v[116:119], v[16:31]
    ds_read_b128 v[220:223], v10 offset:28672
    v_max_f32 v67, 0, v67
    v_max_f32 v72, 0, v72
    v_max_f32 v73, 0, v73
    s_waitcnt lgkmcnt(5)
    v_mfma_f32_32x32x16_bf16 v[16:31], v[228:231], v[120:123], v[16:31]
    ds_read_b128 v[224:227], v10 offset:29696
    v_max_f32 v74, 0, v74
    v_max_f32 v75, 0, v75
    v_mul_f32 v68, v68, v8
    s_waitcnt lgkmcnt(5)
    v_mfma_f32_32x32x16_bf16 v[16:31], v[232:235], v[124:127], v[16:31]
    ds_read_b128 v[228:231], v10 offset:30720
    v_mul_f32 v69, v69, v8
    v_mul_f32 v70, v70, v8
    v_mul_f32 v71, v71, v8
    s_waitcnt lgkmcnt(5)
    v_mfma_f32_32x32x16_bf16 v[16:31], v[236:239], v[128:131], v[16:31]
    ds_read_b128 v[232:235], v10 offset:31744
    v_mul_f32 v76, v76, v8
    v_mul_f32 v77, v77, v8
    v_mul_f32 v78, v78, v8
    s_waitcnt lgkmcnt(5)
    v_mfma_f32_32x32x16_bf16 v[16:31], v[212:215], v[132:135], v[16:31]
    ds_read_b128 v[236:239], v10 offset:32768
    v_mul_f32 v79, v79, v8
    v_mul_f32 v64, v64, v68
    v_mul_f32 v65, v65, v69
    s_waitcnt lgkmcnt(5)
    v_mfma_f32_32x32x16_bf16 v[16:31], v[216:219], v[136:139], v[16:31]
    ds_read_b128 v[212:215], v10 offset:33792
    v_mul_f32 v66, v66, v70
    v_mul_f32 v67, v67, v71
    v_mul_f32 v72, v72, v76
    s_waitcnt lgkmcnt(5)
    v_mfma_f32_32x32x16_bf16 v[16:31], v[220:223], v[140:143], v[16:31]
    ds_read_b128 v[216:219], v10 offset:34816
    v_mul_f32 v73, v73, v77
    v_mul_f32 v74, v74, v78
    v_mul_f32 v75, v75, v79
    s_waitcnt lgkmcnt(5)
    v_mfma_f32_32x32x16_bf16 v[16:31], v[224:227], v[144:147], v[16:31]
    ds_read_b128 v[220:223], v10 offset:35840
    v_cvt_pk_bf16_f32 v68, v64, v65
    v_cvt_pk_bf16_f32 v69, v66, v67
    v_cvt_pk_bf16_f32 v70, v72, v73
    s_waitcnt lgkmcnt(5)
    v_mfma_f32_32x32x16_bf16 v[16:31], v[228:231], v[148:151], v[16:31]
    ds_read_b128 v[224:227], v10 offset:36864
    v_cvt_pk_bf16_f32 v71, v74, v75
    buffer_store_dwordx4 v[68:71], v3, s[24:27], s52 offen offset:3072 sc1
    v_max_f32 v80, 0, v80
    s_waitcnt lgkmcnt(5)
    v_mfma_f32_32x32x16_bf16 v[16:31], v[232:235], v[152:155], v[16:31]
    ds_read_b128 v[228:231], v10 offset:37888
    v_max_f32 v81, 0, v81
    v_max_f32 v82, 0, v82
    v_max_f32 v83, 0, v83
    s_waitcnt lgkmcnt(5)
    v_mfma_f32_32x32x16_bf16 v[16:31], v[236:239], v[156:159], v[16:31]
    ds_read_b128 v[232:235], v10 offset:38912
    v_max_f32 v88, 0, v88
    v_max_f32 v89, 0, v89
    v_max_f32 v90, 0, v90
    s_waitcnt lgkmcnt(5)
    v_mfma_f32_32x32x16_bf16 v[16:31], v[212:215], v[160:163], v[16:31]
    ds_read_b128 v[236:239], v10 offset:39936
    v_max_f32 v91, 0, v91
    v_mul_f32 v84, v84, v8
    v_mul_f32 v85, v85, v8
    s_barrier
    s_waitcnt lgkmcnt(5)
    v_mfma_f32_32x32x16_bf16 v[16:31], v[216:219], v[164:167], v[16:31]
    ds_read_b128 v[212:215], v10 offset:40960
    v_mul_f32 v86, v86, v8
    v_mul_f32 v87, v87, v8
    v_mul_f32 v92, v92, v8
    s_waitcnt lgkmcnt(5)
    v_mfma_f32_32x32x16_bf16 v[16:31], v[220:223], v[168:171], v[16:31]
    ds_read_b128 v[216:219], v10 offset:41984
    v_mul_f32 v93, v93, v8
    v_mul_f32 v94, v94, v8
    v_mul_f32 v95, v95, v8
    s_waitcnt lgkmcnt(5)
    v_mfma_f32_32x32x16_bf16 v[16:31], v[224:227], v[172:175], v[16:31]
    ds_read_b128 v[220:223], v10 offset:43008
    v_mul_f32 v80, v80, v84
    v_mul_f32 v81, v81, v85
    v_mul_f32 v82, v82, v86
    s_waitcnt lgkmcnt(5)
    v_mfma_f32_32x32x16_bf16 v[16:31], v[228:231], v[176:179], v[16:31]
    ds_read_b128 v[224:227], v10 offset:44032
    v_mul_f32 v83, v83, v87
    v_mul_f32 v88, v88, v92
    v_mul_f32 v89, v89, v93
    s_waitcnt lgkmcnt(5)
    v_mfma_f32_32x32x16_bf16 v[16:31], v[232:235], v[180:183], v[16:31]
    ds_read_b128 v[228:231], v10 offset:45056
    v_mul_f32 v90, v90, v94
    v_mul_f32 v91, v91, v95
    v_cvt_pk_bf16_f32 v84, v80, v81
    s_waitcnt lgkmcnt(5)
    v_mfma_f32_32x32x16_bf16 v[16:31], v[236:239], v[184:187], v[16:31]
    ds_read_b128 v[232:235], v10 offset:46080
    v_cvt_pk_bf16_f32 v85, v82, v83
    v_cvt_pk_bf16_f32 v86, v88, v89
    v_cvt_pk_bf16_f32 v87, v90, v91
    s_waitcnt lgkmcnt(5)
    v_mfma_f32_32x32x16_bf16 v[16:31], v[212:215], v[188:191], v[16:31]
    ds_read_b128 v[236:239], v10 offset:47104
    buffer_store_dwordx4 v[84:87], v3, s[24:27], s53 offen offset:0 sc1
    s_waitcnt lgkmcnt(5)
    v_mfma_f32_32x32x16_bf16 v[16:31], v[216:219], v[192:195], v[16:31]
    ds_read_b128 v[212:215], v10 offset:48128
    s_waitcnt lgkmcnt(5)
    v_mfma_f32_32x32x16_bf16 v[16:31], v[220:223], v[196:199], v[16:31]
    ds_read_b128 v[216:219], v10 offset:49152
    s_waitcnt lgkmcnt(5)
    v_mfma_f32_32x32x16_bf16 v[16:31], v[224:227], v[200:203], v[16:31]
    ds_read_b128 v[220:223], v10 offset:50176
    s_waitcnt lgkmcnt(5)
    v_mfma_f32_32x32x16_bf16 v[16:31], v[228:231], v[204:207], v[16:31]
    ds_read_b128 v[224:227], v10 offset:51200
    s_waitcnt lgkmcnt(5)
    v_mfma_f32_32x32x16_bf16 v[16:31], v[232:235], v[208:211], v[16:31]
    ds_read_b128 v[228:231], v10 offset:52224
    s_waitcnt lgkmcnt(5)
    v_mfma_f32_32x32x16_bf16 v[32:47], v[236:239], v[96:99], 0
    ds_read_b128 v[232:235], v10 offset:53248
    s_waitcnt lgkmcnt(5)
    v_mfma_f32_32x32x16_bf16 v[32:47], v[212:215], v[100:103], v[32:47]
    ds_read_b128 v[236:239], v10 offset:54272
    s_waitcnt lgkmcnt(5)
    v_mfma_f32_32x32x16_bf16 v[32:47], v[216:219], v[104:107], v[32:47]
    ds_read_b128 v[212:215], v10 offset:55296
    s_waitcnt lgkmcnt(5)
    v_mfma_f32_32x32x16_bf16 v[32:47], v[220:223], v[108:111], v[32:47]
    ds_read_b128 v[216:219], v10 offset:56320
    s_waitcnt lgkmcnt(5)
    v_mfma_f32_32x32x16_bf16 v[32:47], v[224:227], v[112:115], v[32:47]
    ds_read_b128 v[220:223], v10 offset:57344
    v_max_f32 v16, 0, v16
    v_max_f32 v17, 0, v17
    s_waitcnt lgkmcnt(5)
    v_mfma_f32_32x32x16_bf16 v[32:47], v[228:231], v[116:119], v[32:47]
    ds_read_b128 v[224:227], v10 offset:58368
    v_max_f32 v18, 0, v18
    v_max_f32 v19, 0, v19
    s_waitcnt lgkmcnt(5)
    v_mfma_f32_32x32x16_bf16 v[32:47], v[232:235], v[120:123], v[32:47]
    ds_read_b128 v[228:231], v10 offset:59392
    v_max_f32 v24, 0, v24
    v_max_f32 v25, 0, v25
    s_waitcnt lgkmcnt(5)
    v_mfma_f32_32x32x16_bf16 v[32:47], v[236:239], v[124:127], v[32:47]
    ds_read_b128 v[232:235], v10 offset:60416
    v_max_f32 v26, 0, v26
    v_max_f32 v27, 0, v27
    s_waitcnt lgkmcnt(5)
    v_mfma_f32_32x32x16_bf16 v[32:47], v[212:215], v[128:131], v[32:47]
    ds_read_b128 v[236:239], v10 offset:61440
    v_mul_f32 v20, v20, v8
    v_mul_f32 v21, v21, v8
    s_waitcnt lgkmcnt(5)
    v_mfma_f32_32x32x16_bf16 v[32:47], v[216:219], v[132:135], v[32:47]
    ds_read_b128 v[212:215], v10 offset:62464
    v_mul_f32 v22, v22, v8
    v_mul_f32 v23, v23, v8
    s_waitcnt lgkmcnt(5)
    v_mfma_f32_32x32x16_bf16 v[32:47], v[220:223], v[136:139], v[32:47]
    ds_read_b128 v[216:219], v10 offset:63488
    v_mul_f32 v28, v28, v8
    v_mul_f32 v29, v29, v8
    s_waitcnt lgkmcnt(5)
    v_mfma_f32_32x32x16_bf16 v[32:47], v[224:227], v[140:143], v[32:47]
    ds_read_b128 v[220:223], v10 offset:64512
    v_mul_f32 v30, v30, v8
    v_mul_f32 v31, v31, v8
    s_waitcnt lgkmcnt(5)
    v_mfma_f32_32x32x16_bf16 v[32:47], v[228:231], v[144:147], v[32:47]
    ds_read_b128 v[224:227], v11 offset:0
    v_mul_f32 v16, v16, v20
    v_mul_f32 v17, v17, v21
    s_waitcnt lgkmcnt(5)
    v_mfma_f32_32x32x16_bf16 v[32:47], v[232:235], v[148:151], v[32:47]
    ds_read_b128 v[228:231], v11 offset:1024
    v_mul_f32 v18, v18, v22
    v_mul_f32 v19, v19, v23
    s_waitcnt lgkmcnt(5)
    v_mfma_f32_32x32x16_bf16 v[32:47], v[236:239], v[152:155], v[32:47]
    ds_read_b128 v[232:235], v11 offset:2048
    v_mul_f32 v24, v24, v28
    v_mul_f32 v25, v25, v29
    s_waitcnt lgkmcnt(5)
    v_mfma_f32_32x32x16_bf16 v[32:47], v[212:215], v[156:159], v[32:47]
    ds_read_b128 v[236:239], v11 offset:3072
    v_mul_f32 v26, v26, v30
    v_mul_f32 v27, v27, v31
    s_barrier
    s_waitcnt lgkmcnt(5)
    v_mfma_f32_32x32x16_bf16 v[32:47], v[216:219], v[160:163], v[32:47]
    ds_read_b128 v[212:215], v3 offset:57344
    s_add_u32 s55, s54, 0
    buffer_load_dwordx4 v[96:99], v3, s[24:27], s55 offen offset:0 sc1
    v_cvt_pk_bf16_f32 v20, v16, v17
    v_cvt_pk_bf16_f32 v21, v18, v19
    s_waitcnt lgkmcnt(5)
    v_mfma_f32_32x32x16_bf16 v[32:47], v[220:223], v[164:167], v[32:47]
    ds_read_b128 v[216:219], v3 offset:58368
    buffer_load_dwordx4 v[100:103], v3, s[24:27], s55 offen offset:1024 sc1
    v_cvt_pk_bf16_f32 v22, v24, v25
    v_cvt_pk_bf16_f32 v23, v26, v27
    s_waitcnt lgkmcnt(5)
    v_mfma_f32_32x32x16_bf16 v[32:47], v[224:227], v[168:171], v[32:47]
    ds_read_b128 v[220:223], v3 offset:59392
    buffer_load_dwordx4 v[104:107], v3, s[24:27], s55 offen offset:2048 sc1
    ds_write_b128 v254, v[20:23] offset:0
    s_waitcnt lgkmcnt(5)
    v_mfma_f32_32x32x16_bf16 v[32:47], v[228:231], v[172:175], v[32:47]
    ds_read_b128 v[224:227], v3 offset:60416
    s_add_u32 s55, s54, 7168
    buffer_load_dwordx4 v[108:111], v3, s[24:27], s55 offen offset:0 sc1
    s_waitcnt lgkmcnt(5)
    v_mfma_f32_32x32x16_bf16 v[32:47], v[232:235], v[176:179], v[32:47]
    ds_read_b128 v[228:231], v3 offset:61440
    buffer_load_dwordx4 v[112:115], v3, s[24:27], s55 offen offset:1024 sc1
    s_waitcnt lgkmcnt(5)
    v_mfma_f32_32x32x16_bf16 v[32:47], v[236:239], v[180:183], v[32:47]
    ds_read_b128 v[232:235], v3 offset:62464
    buffer_load_dwordx4 v[116:119], v3, s[24:27], s55 offen offset:2048 sc1
    s_waitcnt lgkmcnt(5)
    v_mfma_f32_32x32x16_bf16 v[32:47], v[212:215], v[184:187], v[32:47]
    ds_read_b128 v[236:239], v3 offset:63488
    s_add_u32 s55, s54, 14336
    buffer_load_dwordx4 v[120:123], v3, s[24:27], s55 offen offset:0 sc1
    s_waitcnt lgkmcnt(5)
    v_mfma_f32_32x32x16_bf16 v[32:47], v[216:219], v[188:191], v[32:47]
    buffer_load_dwordx4 v[124:127], v3, s[24:27], s55 offen offset:1024 sc1
    s_waitcnt lgkmcnt(4)
    v_mfma_f32_32x32x16_bf16 v[32:47], v[220:223], v[192:195], v[32:47]
    buffer_load_dwordx4 v[128:131], v3, s[24:27], s55 offen offset:2048 sc1
    s_waitcnt lgkmcnt(3)
    v_mfma_f32_32x32x16_bf16 v[32:47], v[224:227], v[196:199], v[32:47]
    s_add_u32 s55, s54, 21504
    buffer_load_dwordx4 v[132:135], v3, s[24:27], s55 offen offset:0 sc1
    s_waitcnt lgkmcnt(2)
    v_mfma_f32_32x32x16_bf16 v[32:47], v[228:231], v[200:203], v[32:47]
    buffer_load_dwordx4 v[136:139], v3, s[24:27], s55 offen offset:1024 sc1
    s_waitcnt lgkmcnt(1)
    v_mfma_f32_32x32x16_bf16 v[32:47], v[232:235], v[204:207], v[32:47]
    buffer_load_dwordx4 v[140:143], v3, s[24:27], s55 offen offset:2048 sc1
    s_waitcnt lgkmcnt(0)
    v_mfma_f32_32x32x16_bf16 v[32:47], v[236:239], v[208:211], v[32:47]
    s_nop 11
    v_max_f32 v32, 0, v32
    v_max_f32 v33, 0, v33
    v_max_f32 v34, 0, v34
    v_max_f32 v35, 0, v35
    v_max_f32 v40, 0, v40
    v_max_f32 v41, 0, v41
    v_max_f32 v42, 0, v42
    v_max_f32 v43, 0, v43
    v_pk_mul_f32 v[36:37], v[36:37], v[8:9] op_sel_hi:[1,0]
    v_pk_mul_f32 v[38:39], v[38:39], v[8:9] op_sel_hi:[1,0]
    v_pk_mul_f32 v[44:45], v[44:45], v[8:9] op_sel_hi:[1,0]
    v_pk_mul_f32 v[46:47], v[46:47], v[8:9] op_sel_hi:[1,0]
    v_pk_mul_f32 v[32:33], v[32:33], v[36:37]
    v_pk_mul_f32 v[34:35], v[34:35], v[38:39]
    v_pk_mul_f32 v[40:41], v[40:41], v[44:45]
    v_pk_mul_f32 v[42:43], v[42:43], v[46:47]
    v_cvt_pk_bf16_f32 v36, v32, v33
    v_cvt_pk_bf16_f32 v37, v34, v35
    v_cvt_pk_bf16_f32 v38, v40, v41
    v_cvt_pk_bf16_f32 v39, v42, v43
    ds_write_b128 v254, v[36:39] offset:4096
    ds_read_b64_tr_b16 v[64:65], v252 offset:4096
    ds_read_b64_tr_b16 v[66:67], v252 offset:4608
    ds_read_b64_tr_b16 v[68:69], v253 offset:4096
    ds_read_b64_tr_b16 v[70:71], v253 offset:4608
    ds_read_b64_tr_b16 v[72:73], v252 offset:6144
    ds_read_b64_tr_b16 v[74:75], v252 offset:6656
    ds_read_b64_tr_b16 v[76:77], v253 offset:6144
    ds_read_b64_tr_b16 v[78:79], v253 offset:6656
    s_waitcnt vmcnt(12) lgkmcnt(8)
    s_barrier
    s_cmp_lt_u32 s2, 224
    s_cbranch_scc1 L_n2_39
    s_waitcnt vmcnt(0) lgkmcnt(0)
    s_branch L_fin
L_n2_39:
    s_waitcnt vmcnt(11) lgkmcnt(4)
    v_mfma_f32_32x32x16_bf16 v[16:31], v[64:67], v[96:99], 0
    ds_read_b64_tr_b16 v[80:81], v252 offset:8192
    ds_read_b64_tr_b16 v[82:83], v252 offset:8704
    v_mfma_f32_32x32x16_bf16 v[32:47], v[68:71], v[96:99], 0
    ds_read_b64_tr_b16 v[84:85], v253 offset:8192
    ds_read_b64_tr_b16 v[86:87], v253 offset:8704
    s_add_u32 s55, s54, 28672
    buffer_load_dwordx4 v[144:147], v3, s[24:27], s55 offen offset:0 sc1
    s_waitcnt vmcnt(11) lgkmcnt(4)
    v_mfma_f32_32x32x16_bf16 v[16:31], v[72:75], v[100:103], v[16:31]
    ds_read_b64_tr_b16 v[64:65], v252 offset:10240
    ds_read_b64_tr_b16 v[66:67], v252 offset:10752
    v_mfma_f32_32x32x16_bf16 v[32:47], v[76:79], v[100:103], v[32:47]
    ds_read_b64_tr_b16 v[68:69], v253 offset:10240
    ds_read_b64_tr_b16 v[70:71], v253 offset:10752
    buffer_load_dwordx4 v[148:151], v3, s[24:27], s55 offen offset:1024 sc1
    s_waitcnt vmcnt(11) lgkmcnt(4)
    v_mfma_f32_32x32x16_bf16 v[16:31], v[80:83], v[104:107], v[16:31]
    ds_read_b64_tr_b16 v[72:73], v248 offset:0
    ds_read_b64_tr_b16 v[74:75], v248 offset:512
    v_mfma_f32_32x32x16_bf16 v[32:47], v[84:87], v[104:107], v[32:47]
    ds_read_b64_tr_b16 v[76:77], v249 offset:0
    ds_read_b64_tr_b16 v[78:79], v249 offset:512
    buffer_load_dwordx4 v[152:155], v3, s[24:27], s55 offen offset:2048 sc1
    s_waitcnt vmcnt(11) lgkmcnt(4)
    v_mfma_f32_32x32x16_bf16 v[16:31], v[64:67], v[108:111], v[16:31]
    ds_read_b64_tr_b16 v[80:81], v248 offset:2048
    ds_read_b64_tr_b16 v[82:83], v248 offset:2560
    v_mfma_f32_32x32x16_bf16 v[32:47], v[68:71], v[108:111], v[32:47]
    ds_read_b64_tr_b16 v[84:85], v249 offset:2048
    ds_read_b64_tr_b16 v[86:87], v249 offset:2560
    s_add_u32 s55, s54, 35840
    buffer_load_dwordx4 v[156:159], v3, s[24:27], s55 offen offset:0 sc1
    s_waitcnt vmcnt(11) lgkmcnt(4)
    v_mfma_f32_32x32x16_bf16 v[16:31], v[72:75], v[112:115], v[16:31]
    ds_read_b64_tr_b16 v[64:65], v248 offset:4096
    ds_read_b64_tr_b16 v[66:67], v248 offset:4608
    v_mfma_f32_32x32x16_bf16 v[32:47], v[76:79], v[112:115], v[32:47]
    ds_read_b64_tr_b16 v[68:69], v249 offset:4096
    ds_read_b64_tr_b16 v[70:71], v249 offset:4608
    buffer_load_dwordx4 v[160:163], v3, s[24:27], s55 offen offset:1024 sc1
    s_waitcnt vmcnt(11) lgkmcnt(4)
    v_mfma_f32_32x32x16_bf16 v[16:31], v[80:83], v[116:119], v[16:31]
    ds_read_b64_tr_b16 v[72:73], v248 offset:6144
    ds_read_b64_tr_b16 v[74:75], v248 offset:6656
    v_mfma_f32_32x32x16_bf16 v[32:47], v[84:87], v[116:119], v[32:47]
    ds_read_b64_tr_b16 v[76:77], v249 offset:6144
    ds_read_b64_tr_b16 v[78:79], v249 offset:6656
    buffer_load_dwordx4 v[164:167], v3, s[24:27], s55 offen offset:2048 sc1
    s_waitcnt vmcnt(11) lgkmcnt(4)
    v_mfma_f32_32x32x16_bf16 v[16:31], v[64:67], v[120:123], v[16:31]
    ds_read_b64_tr_b16 v[80:81], v248 offset:16384
    ds_read_b64_tr_b16 v[82:83], v248 offset:16896
    v_mfma_f32_32x32x16_bf16 v[32:47], v[68:71], v[120:123], v[32:47]
    ds_read_b64_tr_b16 v[84:85], v249 offset:16384
    ds_read_b64_tr_b16 v[86:87], v249 offset:16896
    s_add_u32 s55, s54, 43008
    buffer_load_dwordx4 v[168:171], v3, s[24:27], s55 offen offset:0 sc1
    s_waitcnt vmcnt(11) lgkmcnt(4)
    v_mfma_f32_32x32x16_bf16 v[16:31], v[72:75], v[124:127], v[16:31]
    ds_read_b64_tr_b16 v[64:65], v248 offset:18432
    ds_read_b64_tr_b16 v[66:67], v248 offset:18944
    v_mfma_f32_32x32x16_bf16 v[32:47], v[76:79], v[124:127], v[32:47]
    ds_read_b64_tr_b16 v[68:69], v249 offset:18432
    ds_read_b64_tr_b16 v[70:71], v249 offset:18944
    buffer_load_dwordx4 v[172:175], v3, s[24:27], s55 offen offset:1024 sc1
    s_waitcnt vmcnt(11) lgkmcnt(4)
    v_mfma_f32_32x32x16_bf16 v[16:31], v[80:83], v[128:131], v[16:31]
    ds_read_b64_tr_b16 v[72:73], v248 offset:20480
    ds_read_b64_tr_b16 v[74:75], v248 offset:20992
    v_mfma_f32_32x32x16_bf16 v[32:47], v[84:87], v[128:131], v[32:47]
    ds_read_b64_tr_b16 v[76:77], v249 offset:20480
    ds_read_b64_tr_b16 v[78:79], v249 offset:20992
    buffer_load_dwordx4 v[176:179], v3, s[24:27], s55 offen offset:2048 sc1
    s_waitcnt vmcnt(11) lgkmcnt(4)
    v_mfma_f32_32x32x16_bf16 v[16:31], v[64:67], v[132:135], v[16:31]
    ds_read_b64_tr_b16 v[80:81], v248 offset:22528
    ds_read_b64_tr_b16 v[82:83], v248 offset:23040
    v_mfma_f32_32x32x16_bf16 v[32:47], v[68:71], v[132:135], v[32:47]
    ds_read_b64_tr_b16 v[84:85], v249 offset:22528
    ds_read_b64_tr_b16 v[86:87], v249 offset:23040
    s_add_u32 s55, s54, 50176
    buffer_load_dwordx4 v[180:183], v3, s[24:27], s55 offen offset:0 sc1
    s_waitcnt vmcnt(11) lgkmcnt(4)
    v_mfma_f32_32x32x16_bf16 v[16:31], v[72:75], v[136:139], v[16:31]
    ds_read_b64_tr_b16 v[64:65], v248 offset:32768
    ds_read_b64_tr_b16 v[66:67], v248 offset:33280
    v_mfma_f32_32x32x16_bf16 v[32:47], v[76:79], v[136:139], v[32:47]
    ds_read_b64_tr_b16 v[68:69], v249 offset:32768
    ds_read_b64_tr_b16 v[70:71], v249 offset:33280
    buffer_load_dwordx4 v[184:187], v3, s[24:27], s55 offen offset:1024 sc1
    s_waitcnt vmcnt(11) lgkmcnt(4)
    v_mfma_f32_32x32x16_bf16 v[16:31], v[80:83], v[140:143], v[16:31]
    ds_read_b64_tr_b16 v[72:73], v248 offset:34816
    ds_read_b64_tr_b16 v[74:75], v248 offset:35328
    v_mfma_f32_32x32x16_bf16 v[32:47], v[84:87], v[140:143], v[32:47]
    ds_read_b64_tr_b16 v[76:77], v249 offset:34816
    ds_read_b64_tr_b16 v[78:79], v249 offset:35328
    buffer_load_dwordx4 v[188:191], v3, s[24:27], s55 offen offset:2048 sc1
    s_barrier
    s_waitcnt vmcnt(11) lgkmcnt(4)
    v_mfma_f32_32x32x16_bf16 v[16:31], v[64:67], v[144:147], v[16:31]
    ds_read_b64_tr_b16 v[80:81], v248 offset:36864
    ds_read_b64_tr_b16 v[82:83], v248 offset:37376
    v_mfma_f32_32x32x16_bf16 v[32:47], v[68:71], v[144:147], v[32:47]
    ds_read_b64_tr_b16 v[84:85], v249 offset:36864
    ds_read_b64_tr_b16 v[86:87], v249 offset:37376
    s_add_u32 s55, s54, 3072
    buffer_load_dwordx4 v[192:195], v3, s[24:27], s55 offen offset:0 sc1
    s_waitcnt vmcnt(11) lgkmcnt(4)
    v_mfma_f32_32x32x16_bf16 v[16:31], v[72:75], v[148:151], v[16:31]
    ds_read_b64_tr_b16 v[64:65], v248 offset:38912
    ds_read_b64_tr_b16 v[66:67], v248 offset:39424
    v_mfma_f32_32x32x16_bf16 v[32:47], v[76:79], v[148:151], v[32:47]
    ds_read_b64_tr_b16 v[68:69], v249 offset:38912
    ds_read_b64_tr_b16 v[70:71], v249 offset:39424
    buffer_load_dwordx4 v[196:199], v3, s[24:27], s55 offen offset:1024 sc1
    s_waitcnt vmcnt(11) lgkmcnt(4)
    v_mfma_f32_32x32x16_bf16 v[16:31], v[80:83], v[152:155], v[16:31]
    ds_read_b64_tr_b16 v[72:73], v250 offset:0
    ds_read_b64_tr_b16 v[74:75], v250 offset:512
    v_mfma_f32_32x32x16_bf16 v[32:47], v[84:87], v[152:155], v[32:47]
    ds_read_b64_tr_b16 v[76:77], v251 offset:0
    ds_read_b64_tr_b16 v[78:79], v251 offset:512
    s_add_u32 s55, s54, 10240
    buffer_load_dwordx4 v[200:203], v3, s[24:27], s55 offen offset:0 sc1
    s_waitcnt vmcnt(11) lgkmcnt(4)
    v_mfma_f32_32x32x16_bf16 v[16:31], v[64:67], v[156:159], v[16:31]
    ds_read_b64_tr_b16 v[80:81], v250 offset:2048
    ds_read_b64_tr_b16 v[82:83], v250 offset:2560
    v_mfma_f32_32x32x16_bf16 v[32:47], v[68:71], v[156:159], v[32:47]
    ds_read_b64_tr_b16 v[84:85], v251 offset:2048
    ds_read_b64_tr_b16 v[86:87], v251 offset:2560
    buffer_load_dwordx4 v[204:207], v3, s[24:27], s55 offen offset:1024 sc1
    s_waitcnt vmcnt(11) lgkmcnt(4)
    v_mfma_f32_32x32x16_bf16 v[16:31], v[72:75], v[160:163], v[16:31]
    ds_read_b64_tr_b16 v[64:65], v250 offset:4096
    ds_read_b64_tr_b16 v[66:67], v250 offset:4608
    v_mfma_f32_32x32x16_bf16 v[32:47], v[76:79], v[160:163], v[32:47]
    ds_read_b64_tr_b16 v[68:69], v251 offset:4096
    ds_read_b64_tr_b16 v[70:71], v251 offset:4608
    s_add_u32 s55, s54, 17408
    buffer_load_dwordx4 v[208:211], v3, s[24:27], s55 offen offset:0 sc1
    s_waitcnt vmcnt(11) lgkmcnt(4)
    v_mfma_f32_32x32x16_bf16 v[16:31], v[80:83], v[164:167], v[16:31]
    ds_read_b64_tr_b16 v[72:73], v250 offset:6144
    ds_read_b64_tr_b16 v[74:75], v250 offset:6656
    v_mfma_f32_32x32x16_bf16 v[32:47], v[84:87], v[164:167], v[32:47]
    ds_read_b64_tr_b16 v[76:77], v251 offset:6144
    ds_read_b64_tr_b16 v[78:79], v251 offset:6656
    buffer_load_dwordx4 v[212:215], v3, s[24:27], s55 offen offset:1024 sc1
    s_waitcnt vmcnt(11) lgkmcnt(4)
    v_mfma_f32_32x32x16_bf16 v[16:31], v[64:67], v[168:171], v[16:31]
    ds_read_b64_tr_b16 v[80:81], v250 offset:16384
    ds_read_b64_tr_b16 v[82:83], v250 offset:16896
    v_mfma_f32_32x32x16_bf16 v[32:47], v[68:71], v[168:171], v[32:47]
    ds_read_b64_tr_b16 v[84:85], v251 offset:16384
    ds_read_b64_tr_b16 v[86:87], v251 offset:16896
    s_add_u32 s55, s54, 24576
    buffer_load_dwordx4 v[216:219], v3, s[24:27], s55 offen offset:0 sc1
    s_waitcnt vmcnt(11) lgkmcnt(4)
    v_mfma_f32_32x32x16_bf16 v[16:31], v[72:75], v[172:175], v[16:31]
    ds_read_b64_tr_b16 v[64:65], v250 offset:18432
    ds_read_b64_tr_b16 v[66:67], v250 offset:18944
    v_mfma_f32_32x32x16_bf16 v[32:47], v[76:79], v[172:175], v[32:47]
    ds_read_b64_tr_b16 v[68:69], v251 offset:18432
    ds_read_b64_tr_b16 v[70:71], v251 offset:18944
    buffer_load_dwordx4 v[220:223], v3, s[24:27], s55 offen offset:1024 sc1
    s_waitcnt vmcnt(11) lgkmcnt(4)
    v_mfma_f32_32x32x16_bf16 v[16:31], v[80:83], v[176:179], v[16:31]
    ds_read_b64_tr_b16 v[72:73], v250 offset:20480
    ds_read_b64_tr_b16 v[74:75], v250 offset:20992
    v_mfma_f32_32x32x16_bf16 v[32:47], v[84:87], v[176:179], v[32:47]
    ds_read_b64_tr_b16 v[76:77], v251 offset:20480
    ds_read_b64_tr_b16 v[78:79], v251 offset:20992
    s_add_u32 s55, s54, 31744
    buffer_load_dwordx4 v[96:99], v3, s[24:27], s55 offen offset:0 sc1
    s_waitcnt vmcnt(11) lgkmcnt(4)
    v_mfma_f32_32x32x16_bf16 v[16:31], v[64:67], v[180:183], v[16:31]
    ds_read_b64_tr_b16 v[80:81], v250 offset:22528
    ds_read_b64_tr_b16 v[82:83], v250 offset:23040
    v_mfma_f32_32x32x16_bf16 v[32:47], v[68:71], v[180:183], v[32:47]
    ds_read_b64_tr_b16 v[84:85], v251 offset:22528
    ds_read_b64_tr_b16 v[86:87], v251 offset:23040
    buffer_load_dwordx4 v[100:103], v3, s[24:27], s55 offen offset:1024 sc1
    s_barrier
    s_waitcnt vmcnt(11) lgkmcnt(4)
    v_mfma_f32_32x32x16_bf16 v[16:31], v[72:75], v[184:187], v[16:31]
    ds_read_b64_tr_b16 v[64:65], v250 offset:32768
    ds_read_b64_tr_b16 v[66:67], v250 offset:33280
    v_mfma_f32_32x32x16_bf16 v[32:47], v[76:79], v[184:187], v[32:47]
    ds_read_b64_tr_b16 v[68:69], v251 offset:32768
    ds_read_b64_tr_b16 v[70:71], v251 offset:33280
    s_add_u32 s55, s54, 38912
    buffer_load_dwordx4 v[104:107], v3, s[24:27], s55 offen offset:0 sc1
    s_waitcnt vmcnt(11) lgkmcnt(4)
    v_mfma_f32_32x32x16_bf16 v[16:31], v[80:83], v[188:191], v[16:31]
    ds_read_b64_tr_b16 v[72:73], v250 offset:34816
    ds_read_b64_tr_b16 v[74:75], v250 offset:35328
    v_mfma_f32_32x32x16_bf16 v[32:47], v[84:87], v[188:191], v[32:47]
    ds_read_b64_tr_b16 v[76:77], v251 offset:34816
    ds_read_b64_tr_b16 v[78:79], v251 offset:35328
    buffer_load_dwordx4 v[108:111], v3, s[24:27], s55 offen offset:1024 sc1
    s_waitcnt vmcnt(11) lgkmcnt(4)
    v_mfma_f32_32x32x16_bf16 v[16:31], v[64:67], v[192:195], v[16:31]
    ds_read_b64_tr_b16 v[80:81], v250 offset:36864
    ds_read_b64_tr_b16 v[82:83], v250 offset:37376
    v_mfma_f32_32x32x16_bf16 v[32:47], v[68:71], v[192:195], v[32:47]
    ds_read_b64_tr_b16 v[84:85], v251 offset:36864
    ds_read_b64_tr_b16 v[86:87], v251 offset:37376
    s_add_u32 s55, s54, 46080
    buffer_load_dwordx4 v[112:115], v3, s[24:27], s55 offen offset:0 sc1
    s_waitcnt vmcnt(11) lgkmcnt(4)
    v_mfma_f32_32x32x16_bf16 v[16:31], v[72:75], v[196:199], v[16:31]
    ds_read_b64_tr_b16 v[64:65], v250 offset:38912
    ds_read_b64_tr_b16 v[66:67], v250 offset:39424
    v_mfma_f32_32x32x16_bf16 v[32:47], v[76:79], v[196:199], v[32:47]
    ds_read_b64_tr_b16 v[68:69], v251 offset:38912
    ds_read_b64_tr_b16 v[70:71], v251 offset:39424
    buffer_load_dwordx4 v[116:119], v3, s[24:27], s55 offen offset:1024 sc1
    s_waitcnt vmcnt(11) lgkmcnt(4)
    v_mfma_f32_32x32x16_bf16 v[16:31], v[80:83], v[200:203], v[16:31]
    ds_read_b64_tr_b16 v[72:73], v250 offset:49152
    ds_read_b64_tr_b16 v[74:75], v250 offset:49664
    v_mfma_f32_32x32x16_bf16 v[32:47], v[84:87], v[200:203], v[32:47]
    ds_read_b64_tr_b16 v[76:77], v251 offset:49152
    ds_read_b64_tr_b16 v[78:79], v251 offset:49664
    s_add_u32 s55, s54, 53248
    buffer_load_dwordx4 v[120:123], v3, s[24:27], s55 offen offset:0 sc1
    s_waitcnt vmcnt(11) lgkmcnt(4)
    v_mfma_f32_32x32x16_bf16 v[16:31], v[64:67], v[204:207], v[16:31]
    ds_read_b64_tr_b16 v[80:81], v250 offset:51200
    ds_read_b64_tr_b16 v[82:83], v250 offset:51712
    v_mfma_f32_32x32x16_bf16 v[32:47], v[68:71], v[204:207], v[32:47]
    ds_read_b64_tr_b16 v[84:85], v251 offset:51200
    ds_read_b64_tr_b16 v[86:87], v251 offset:51712
    buffer_load_dwordx4 v[124:127], v3, s[24:27], s55 offen offset:1024 sc1
    s_barrier
    s_waitcnt vmcnt(11) lgkmcnt(4)
    v_mfma_f32_32x32x16_bf16 v[16:31], v[72:75], v[208:211], v[16:31]
    ds_read_b64_tr_b16 v[64:65], v250 offset:53248
    ds_read_b64_tr_b16 v[66:67], v250 offset:53760
    v_mfma_f32_32x32x16_bf16 v[32:47], v[76:79], v[208:211], v[32:47]
    ds_read_b64_tr_b16 v[68:69], v251 offset:53248
    ds_read_b64_tr_b16 v[70:71], v251 offset:53760
    s_add_u32 s55, s54, 5120
    buffer_load_dwordx4 v[128:131], v3, s[24:27], s55 offen offset:0 sc1
    s_waitcnt vmcnt(11) lgkmcnt(4)
    v_mfma_f32_32x32x16_bf16 v[16:31], v[80:83], v[212:215], v[16:31]
    ds_read_b64_tr_b16 v[72:73], v250 offset:55296
    ds_read_b64_tr_b16 v[74:75], v250 offset:55808
    v_mfma_f32_32x32x16_bf16 v[32:47], v[84:87], v[212:215], v[32:47]
    ds_read_b64_tr_b16 v[76:77], v251 offset:55296
    ds_read_b64_tr_b16 v[78:79], v251 offset:55808
    buffer_load_dwordx4 v[132:135], v3, s[24:27], s55 offen offset:1024 sc1
    s_waitcnt vmcnt(11) lgkmcnt(4)
    v_mfma_f32_32x32x16_bf16 v[16:31], v[64:67], v[216:219], v[16:31]
    ds_read_b64_tr_b16 v[80:81], v248 offset:49152
    ds_read_b64_tr_b16 v[82:83], v248 offset:49664
    v_mfma_f32_32x32x16_bf16 v[32:47], v[68:71], v[216:219], v[32:47]
    ds_read_b64_tr_b16 v[84:85], v249 offset:49152
    ds_read_b64_tr_b16 v[86:87], v249 offset:49664
    s_add_u32 s55, s54, 12288
    buffer_load_dwordx4 v[136:139], v3, s[24:27], s55 offen offset:0 sc1
    s_waitcnt vmcnt(11) lgkmcnt(4)
    v_mfma_f32_32x32x16_bf16 v[16:31], v[72:75], v[220:223], v[16:31]
    ds_read_b64_tr_b16 v[64:65], v248 offset:51200
    ds_read_b64_tr_b16 v[66:67], v248 offset:51712
    v_mfma_f32_32x32x16_bf16 v[32:47], v[76:79], v[220:223], v[32:47]
    ds_read_b64_tr_b16 v[68:69], v249 offset:51200
    ds_read_b64_tr_b16 v[70:71], v249 offset:51712
    buffer_load_dwordx4 v[140:143], v3, s[24:27], s55 offen offset:1024 sc1
    s_waitcnt vmcnt(11) lgkmcnt(4)
    v_mfma_f32_32x32x16_bf16 v[16:31], v[80:83], v[96:99], v[16:31]
    ds_read_b64_tr_b16 v[72:73], v248 offset:53248
    ds_read_b64_tr_b16 v[74:75], v248 offset:53760
    v_mfma_f32_32x32x16_bf16 v[32:47], v[84:87], v[96:99], v[32:47]
    ds_read_b64_tr_b16 v[76:77], v249 offset:53248
    ds_read_b64_tr_b16 v[78:79], v249 offset:53760
    s_add_u32 s55, s54, 19456
    buffer_load_dwordx4 v[144:147], v3, s[24:27], s55 offen offset:0 sc1
    s_waitcnt vmcnt(11) lgkmcnt(4)
    v_mfma_f32_32x32x16_bf16 v[16:31], v[64:67], v[100:103], v[16:31]
    ds_read_b64_tr_b16 v[80:81], v248 offset:55296
    ds_read_b64_tr_b16 v[82:83], v248 offset:55808
    v_mfma_f32_32x32x16_bf16 v[32:47], v[68:71], v[100:103], v[32:47]
    ds_read_b64_tr_b16 v[84:85], v249 offset:55296
    ds_read_b64_tr_b16 v[86:87], v249 offset:55808
    buffer_load_dwordx4 v[148:151], v3, s[24:27], s55 offen offset:1024 sc1
    s_barrier
    s_waitcnt vmcnt(11) lgkmcnt(4)
    v_mfma_f32_32x32x16_bf16 v[16:31], v[72:75], v[104:107], v[16:31]
    ds_read_b64_tr_b16 v[64:65], v252 offset:4096
    ds_read_b64_tr_b16 v[66:67], v252 offset:4608
    v_mfma_f32_32x32x16_bf16 v[32:47], v[76:79], v[104:107], v[32:47]
    ds_read_b64_tr_b16 v[68:69], v253 offset:4096
    ds_read_b64_tr_b16 v[70:71], v253 offset:4608
    s_add_u32 s55, s54, 26624
    buffer_load_dwordx4 v[152:155], v3, s[24:27], s55 offen offset:0 sc1
    s_waitcnt vmcnt(11) lgkmcnt(4)
    v_mfma_f32_32x32x16_bf16 v[16:31], v[80:83], v[108:111], v[16:31]
    ds_read_b64_tr_b16 v[72:73], v252 offset:6144
    ds_read_b64_tr_b16 v[74:75], v252 offset:6656
    v_mfma_f32_32x32x16_bf16 v[32:47], v[84:87], v[108:111], v[32:47]
    ds_read_b64_tr_b16 v[76:77], v253 offset:6144
    ds_read_b64_tr_b16 v[78:79], v253 offset:6656
    buffer_load_dwordx4 v[156:159], v3, s[24:27], s55 offen offset:1024 sc1
    s_waitcnt vmcnt(11) lgkmcnt(4)
    v_mfma_f32_32x32x16_bf16 v[16:31], v[64:67], v[112:115], v[16:31]
    ds_read_b64_tr_b16 v[80:81], v252 offset:8192
    ds_read_b64_tr_b16 v[82:83], v252 offset:8704
    v_mfma_f32_32x32x16_bf16 v[32:47], v[68:71], v[112:115], v[32:47]
    ds_read_b64_tr_b16 v[84:85], v253 offset:8192
    ds_read_b64_tr_b16 v[86:87], v253 offset:8704
    s_add_u32 s55, s54, 33792
    buffer_load_dwordx4 v[160:163], v3, s[24:27], s55 offen offset:0 sc1
    s_waitcnt vmcnt(11) lgkmcnt(4)
    v_mfma_f32_32x32x16_bf16 v[16:31], v[72:75], v[116:119], v[16:31]
    ds_read_b64_tr_b16 v[64:65], v252 offset:10240
    ds_read_b64_tr_b16 v[66:67], v252 offset:10752
    v_mfma_f32_32x32x16_bf16 v[32:47], v[76:79], v[116:119], v[32:47]
    ds_read_b64_tr_b16 v[68:69], v253 offset:10240
    ds_read_b64_tr_b16 v[70:71], v253 offset:10752
    buffer_load_dwordx4 v[164:167], v3, s[24:27], s55 offen offset:1024 sc1
    s_waitcnt vmcnt(11) lgkmcnt(4)
    v_mfma_f32_32x32x16_bf16 v[16:31], v[80:83], v[120:123], v[16:31]
    ds_read_b64_tr_b16 v[72:73], v248 offset:0
    ds_read_b64_tr_b16 v[74:75], v248 offset:512
    v_mfma_f32_32x32x16_bf16 v[32:47], v[84:87], v[120:123], v[32:47]
    ds_read_b64_tr_b16 v[76:77], v249 offset:0
    ds_read_b64_tr_b16 v[78:79], v249 offset:512
    s_add_u32 s55, s54, 40960
    buffer_load_dwordx4 v[168:171], v3, s[24:27], s55 offen offset:0 sc1
    s_waitcnt vmcnt(11) lgkmcnt(4)
    v_mfma_f32_32x32x16_bf16 v[16:31], v[64:67], v[124:127], v[16:31]
    ds_read_b64_tr_b16 v[80:81], v248 offset:2048
    ds_read_b64_tr_b16 v[82:83], v248 offset:2560
    v_mfma_f32_32x32x16_bf16 v[32:47], v[68:71], v[124:127], v[32:47]
    ds_read_b64_tr_b16 v[84:85], v249 offset:2048
    ds_read_b64_tr_b16 v[86:87], v249 offset:2560
    buffer_load_dwordx4 v[172:175], v3, s[24:27], s55 offen offset:1024 sc1
    s_waitcnt vmcnt(11) lgkmcnt(4)
    v_mfma_f32_32x32x16_bf16 v[16:31], v[72:75], v[128:131], v[16:31]
    ds_read_b64_tr_b16 v[64:65], v248 offset:4096
    ds_read_b64_tr_b16 v[66:67], v248 offset:4608
    v_mfma_f32_32x32x16_bf16 v[32:47], v[76:79], v[128:131], v[32:47]
    ds_read_b64_tr_b16 v[68:69], v249 offset:4096
    ds_read_b64_tr_b16 v[70:71], v249 offset:4608
    s_add_u32 s55, s54, 48128
    buffer_load_dwordx4 v[176:179], v3, s[24:27], s55 offen offset:0 sc1
    s_waitcnt vmcnt(11) lgkmcnt(4)
    v_mfma_f32_32x32x16_bf16 v[16:31], v[80:83], v[132:135], v[16:31]
    ds_read_b64_tr_b16 v[72:73], v248 offset:6144
    ds_read_b64_tr_b16 v[74:75], v248 offset:6656
    v_mfma_f32_32x32x16_bf16 v[32:47], v[84:87], v[132:135], v[32:47]
    ds_read_b64_tr_b16 v[76:77], v249 offset:6144
    ds_read_b64_tr_b16 v[78:79], v249 offset:6656
    buffer_load_dwordx4 v[180:183], v3, s[24:27], s55 offen offset:1024 sc1
    s_waitcnt vmcnt(11) lgkmcnt(4)
    v_mfma_f32_32x32x16_bf16 v[16:31], v[64:67], v[136:139], v[16:31]
    ds_read_b64_tr_b16 v[80:81], v248 offset:16384
    ds_read_b64_tr_b16 v[82:83], v248 offset:16896
    v_mfma_f32_32x32x16_bf16 v[32:47], v[68:71], v[136:139], v[32:47]
    ds_read_b64_tr_b16 v[84:85], v249 offset:16384
    ds_read_b64_tr_b16 v[86:87], v249 offset:16896
    s_add_u32 s55, s54, 55296
    buffer_load_dwordx4 v[184:187], v3, s[24:27], s55 offen offset:0 sc1
    s_waitcnt vmcnt(11) lgkmcnt(4)
    v_mfma_f32_32x32x16_bf16 v[16:31], v[72:75], v[140:143], v[16:31]
    ds_read_b64_tr_b16 v[64:65], v248 offset:18432
    ds_read_b64_tr_b16 v[66:67], v248 offset:18944
    v_mfma_f32_32x32x16_bf16 v[32:47], v[76:79], v[140:143], v[32:47]
    ds_read_b64_tr_b16 v[68:69], v249 offset:18432
    ds_read_b64_tr_b16 v[70:71], v249 offset:18944
    buffer_load_dwordx4 v[188:191], v3, s[24:27], s55 offen offset:1024 sc1
    s_barrier
    s_waitcnt vmcnt(11) lgkmcnt(4)
    v_mfma_f32_32x32x16_bf16 v[16:31], v[80:83], v[144:147], v[16:31]
    ds_read_b64_tr_b16 v[72:73], v248 offset:20480
    ds_read_b64_tr_b16 v[74:75], v248 offset:20992
    v_mfma_f32_32x32x16_bf16 v[32:47], v[84:87], v[144:147], v[32:47]
    ds_read_b64_tr_b16 v[76:77], v249 offset:20480
    ds_read_b64_tr_b16 v[78:79], v249 offset:20992
    s_waitcnt vmcnt(10) lgkmcnt(4)
    v_mfma_f32_32x32x16_bf16 v[16:31], v[64:67], v[148:151], v[16:31]
    ds_read_b64_tr_b16 v[80:81], v248 offset:22528
    ds_read_b64_tr_b16 v[82:83], v248 offset:23040
    v_mfma_f32_32x32x16_bf16 v[32:47], v[68:71], v[148:151], v[32:47]
    ds_read_b64_tr_b16 v[84:85], v249 offset:22528
    ds_read_b64_tr_b16 v[86:87], v249 offset:23040
    s_waitcnt vmcnt(9) lgkmcnt(4)
    v_mfma_f32_32x32x16_bf16 v[16:31], v[72:75], v[152:155], v[16:31]
    ds_read_b64_tr_b16 v[64:65], v248 offset:32768
    ds_read_b64_tr_b16 v[66:67], v248 offset:33280
    v_mfma_f32_32x32x16_bf16 v[32:47], v[76:79], v[152:155], v[32:47]
    ds_read_b64_tr_b16 v[68:69], v249 offset:32768
    ds_read_b64_tr_b16 v[70:71], v249 offset:33280
    s_waitcnt vmcnt(8) lgkmcnt(4)
    v_mfma_f32_32x32x16_bf16 v[16:31], v[80:83], v[156:159], v[16:31]
    ds_read_b64_tr_b16 v[72:73], v248 offset:34816
    ds_read_b64_tr_b16 v[74:75], v248 offset:35328
    v_mfma_f32_32x32x16_bf16 v[32:47], v[84:87], v[156:159], v[32:47]
    ds_read_b64_tr_b16 v[76:77], v249 offset:34816
    ds_read_b64_tr_b16 v[78:79], v249 offset:35328
    s_waitcnt vmcnt(7) lgkmcnt(4)
    v_mfma_f32_32x32x16_bf16 v[16:31], v[64:67], v[160:163], v[16:31]
    ds_read_b64_tr_b16 v[80:81], v248 offset:36864
    ds_read_b64_tr_b16 v[82:83], v248 offset:37376
    v_mfma_f32_32x32x16_bf16 v[32:47], v[68:71], v[160:163], v[32:47]
    ds_read_b64_tr_b16 v[84:85], v249 offset:36864
    ds_read_b64_tr_b16 v[86:87], v249 offset:37376
    s_waitcnt vmcnt(6) lgkmcnt(4)
    v_mfma_f32_32x32x16_bf16 v[16:31], v[72:75], v[164:167], v[16:31]
    ds_read_b64_tr_b16 v[64:65], v248 offset:38912
    ds_read_b64_tr_b16 v[66:67], v248 offset:39424
    v_mfma_f32_32x32x16_bf16 v[32:47], v[76:79], v[164:167], v[32:47]
    ds_read_b64_tr_b16 v[68:69], v249 offset:38912
    ds_read_b64_tr_b16 v[70:71], v249 offset:39424
    s_waitcnt vmcnt(5) lgkmcnt(4)
    v_mfma_f32_32x32x16_bf16 v[16:31], v[80:83], v[168:171], v[16:31]
    ds_read_b64_tr_b16 v[72:73], v250 offset:0
    ds_read_b64_tr_b16 v[74:75], v250 offset:512
    v_mfma_f32_32x32x16_bf16 v[32:47], v[84:87], v[168:171], v[32:47]
    ds_read_b64_tr_b16 v[76:77], v251 offset:0
    ds_read_b64_tr_b16 v[78:79], v251 offset:512
    s_waitcnt vmcnt(4) lgkmcnt(4)
    v_mfma_f32_32x32x16_bf16 v[16:31], v[64:67], v[172:175], v[16:31]
    ds_read_b64_tr_b16 v[80:81], v250 offset:2048
    ds_read_b64_tr_b16 v[82:83], v250 offset:2560
    v_mfma_f32_32x32x16_bf16 v[32:47], v[68:71], v[172:175], v[32:47]
    ds_read_b64_tr_b16 v[84:85], v251 offset:2048
    ds_read_b64_tr_b16 v[86:87], v251 offset:2560
    s_waitcnt vmcnt(3) lgkmcnt(4)
    v_mfma_f32_32x32x16_bf16 v[16:31], v[72:75], v[176:179], v[16:31]
    ds_read_b64_tr_b16 v[64:65], v250 offset:4096
    ds_read_b64_tr_b16 v[66:67], v250 offset:4608
    v_mfma_f32_32x32x16_bf16 v[32:47], v[76:79], v[176:179], v[32:47]
    ds_read_b64_tr_b16 v[68:69], v251 offset:4096
    ds_read_b64_tr_b16 v[70:71], v251 offset:4608
    s_waitcnt vmcnt(2) lgkmcnt(4)
    v_mfma_f32_32x32x16_bf16 v[16:31], v[80:83], v[180:183], v[16:31]
    ds_read_b64_tr_b16 v[72:73], v250 offset:6144
    ds_read_b64_tr_b16 v[74:75], v250 offset:6656
    v_mfma_f32_32x32x16_bf16 v[32:47], v[84:87], v[180:183], v[32:47]
    ds_read_b64_tr_b16 v[76:77], v251 offset:6144
    ds_read_b64_tr_b16 v[78:79], v251 offset:6656
    s_waitcnt vmcnt(1) lgkmcnt(4)
    v_mfma_f32_32x32x16_bf16 v[16:31], v[64:67], v[184:187], v[16:31]
    v_mfma_f32_32x32x16_bf16 v[32:47], v[68:71], v[184:187], v[32:47]
    s_waitcnt vmcnt(0) lgkmcnt(0)
    v_mfma_f32_32x32x16_bf16 v[16:31], v[72:75], v[188:191], v[16:31]
    v_mfma_f32_32x32x16_bf16 v[32:47], v[76:79], v[188:191], v[32:47]
    s_lshl_b32 s46, s3, 12
    s_xor_b32 s47, s3, 2
    s_lshl_b32 s47, s47, 12
    s_add_u32 s46, s46, 81920
    s_add_u32 s47, s47, 81920
    v_add_u32 v6, s46, v3
    v_add_u32 v7, s47, v3
    s_nop 4
    s_cmp_lg_u32 s43, 0
    s_cbranch_scc1 L_h1_40
    ds_write_b128 v6, v[32:35] offset:0
    ds_write_b128 v6, v[36:39] offset:1024
    ds_write_b128 v6, v[40:43] offset:2048
    ds_write_b128 v6, v[44:47] offset:3072
    s_branch L_hj_41
L_h1_40:
    ds_write_b128 v6, v[16:19] offset:0
    ds_write_b128 v6, v[20:23] offset:1024
    ds_write_b128 v6, v[24:27] offset:2048
    ds_write_b128 v6, v[28:31] offset:3072
    s_nop 1
    v_pk_mov_b32 v[16:17], v[32:33], v[32:33] op_sel:[0,1]
    v_pk_mov_b32 v[18:19], v[34:35], v[34:35] op_sel:[0,1]
    v_pk_mov_b32 v[20:21], v[36:37], v[36:37] op_sel:[0,1]
    v_pk_mov_b32 v[22:23], v[38:39], v[38:39] op_sel:[0,1]
    v_pk_mov_b32 v[24:25], v[40:41], v[40:41] op_sel:[0,1]
    v_pk_mov_b32 v[26:27], v[42:43], v[42:43] op_sel:[0,1]
    v_pk_mov_b32 v[28:29], v[44:45], v[44:45] op_sel:[0,1]
    v_pk_mov_b32 v[30:31], v[46:47], v[46:47] op_sel:[0,1]
L_hj_41:
    v_lshlrev_b32 v8, 16, v240
    v_and_b32 v9, 0xffff0000, v240
    v_pk_add_f32 v[16:17], v[16:17], v[8:9]
    v_lshlrev_b32 v8, 16, v241
    v_and_b32 v9, 0xffff0000, v241
    v_pk_add_f32 v[18:19], v[18:19], v[8:9]
    v_lshlrev_b32 v8, 16, v242
    v_and_b32 v9, 0xffff0000, v242
    v_pk_add_f32 v[20:21], v[20:21], v[8:9]
    v_lshlrev_b32 v8, 16, v243
    v_and_b32 v9, 0xffff0000, v243
    v_pk_add_f32 v[22:23], v[22:23], v[8:9]
    v_lshlrev_b32 v8, 16, v244
    v_and_b32 v9, 0xffff0000, v244
    v_pk_add_f32 v[24:25], v[24:25], v[8:9]
    v_lshlrev_b32 v8, 16, v245
    v_and_b32 v9, 0xffff0000, v245
    v_pk_add_f32 v[26:27], v[26:27], v[8:9]
    v_lshlrev_b32 v8, 16, v246
    v_and_b32 v9, 0xffff0000, v246
    v_pk_add_f32 v[28:29], v[28:29], v[8:9]
    v_lshlrev_b32 v8, 16, v247
    v_and_b32 v9, 0xffff0000, v247
    v_pk_add_f32 v[30:31], v[30:31], v[8:9]
    s_waitcnt lgkmcnt(0)
    s_barrier
    ds_read_b128 v[48:51], v7 offset:0
    ds_read_b128 v[52:55], v7 offset:1024
    ds_read_b128 v[56:59], v7 offset:2048
    ds_read_b128 v[60:63], v7 offset:3072
    s_waitcnt lgkmcnt(3)
    v_pk_add_f32 v[16:17], v[16:17], v[48:49]
    v_pk_add_f32 v[18:19], v[18:19], v[50:51]
    s_waitcnt lgkmcnt(2)
    v_pk_add_f32 v[20:21], v[20:21], v[52:53]
    v_pk_add_f32 v[22:23], v[22:23], v[54:55]
    s_waitcnt lgkmcnt(1)
    v_pk_add_f32 v[24:25], v[24:25], v[56:57]
    v_pk_add_f32 v[26:27], v[26:27], v[58:59]
    s_waitcnt lgkmcnt(0)
    v_pk_add_f32 v[28:29], v[28:29], v[60:61]
    v_pk_add_f32 v[30:31], v[30:31], v[62:63]
    v_cvt_pk_bf16_f32 v240, v16, v17
    v_cvt_pk_bf16_f32 v241, v18, v19
    v_cvt_pk_bf16_f32 v242, v20, v21
    v_cvt_pk_bf16_f32 v243, v22, v23
    v_cvt_pk_bf16_f32 v244, v24, v25
    v_cvt_pk_bf16_f32 v245, v26, v27
    v_cvt_pk_bf16_f32 v246, v28, v29
    v_cvt_pk_bf16_f32 v247, v30, v31
    v_mul_u32_u24 v5, 896, v2
    v_lshl_add_u32 v5, v1, 5, v5
    s_mul_i32 s46, s44, 28672
    s_lshl_b32 s47, s45, 6
    s_add_u32 s46, s46, s47
    buffer_store_dwordx4 v[240:243], v5, s[28:31], s46 offen
    buffer_store_dwordx4 v[244:247], v5, s[28:31], s46 offen offset:16
L_fin:
    s_endpgm
L_LD:
    s_lshl_b32 s40, s36, 2
    s_and_b32 s41, s37, 3
    s_add_u32 s40, s40, s41
    s_lshr_b32 s41, s37, 2
    s_mov_b32 s32, s20
    s_mov_b32 s33, s21
    s_mov_b32 s34, 256
    s_mov_b32 s35, 0x20000
    buffer_load_dword v9, off, s[32:35], 0 sc1
    s_and_b32 s46, s40, 30
    v_and_b32 v4, 1, v0
    v_add_u32 v4, s46, v4
    v_bfe_u32 v5, v0, 1, 3
    v_lshl_add_u32 v4, v4, 3, v5
    v_lshlrev_b32 v4, 7, v4
    v_mov_b32 v10, v6
    v_mov_b32 v11, v7
    s_waitcnt vmcnt(0)
    s_barrier
    v_readfirstlane_b32 s97, v9
    s_cmp_lg_u32 s3, 4
    s_cbranch_scc1 L_n0_42
    s_lshl_b32 s58, s2, 7
    s_add_u32 s58, s58, 20447232
    v_mov_b32 v5, 2
    s_mov_b64 exec, 1
    buffer_store_dword v5, off, s[24:27], s58 sc1
    s_mov_b64 exec, -1
    s_cmp_ge_u32 s2, 224
    s_cbranch_scc1 L_n0_42
    s_mov_b32 s58, 0x100000
    s_mov_b32 s59, 20447232
L_poll_45:
    buffer_load_dword v5, v4, s[24:27], s59 offen sc1
    s_sub_u32 s58, s58, 1
    s_cmp_eq_u32 s58, 0
    s_cbranch_scc1 L_polld_46
    s_waitcnt vmcnt(0)
    v_cmp_gt_u32 vcc, 2, v5
    s_nop 0
    s_cbranch_vccnz L_poll_45
L_polld_46:
L_n0_42:
    s_cmp_ge_u32 s2, 224
    s_cbranch_scc1 L_l3_43
    s_barrier
L_l3_43:
    s_mov_b32 s28, s16
    s_mov_b32 s29, s17
    s_mov_b32 s30, 1605632
    s_mov_b32 s31, 0x20000
    v_lshrrev_b32 v6, 3, v0
    v_bfe_u32 v7, v0, 4, 1
    v_lshlrev_b32 v7, 2, v7
    v_and_b32 v8, 7, v0
    v_xor_b32 v7, v7, v8
    v_mul_u32_u24 v6, 896, v6
    v_lshl_add_u32 v4, v7, 4, v6
    s_lshr_b32 s42, s38, 1
    s_mul_i32 s42, s42, 802816
    s_and_b32 s43, s38, 1
    s_mul_i32 s43, s43, 7168
    s_add_u32 s42, s42, s43
    s_lshl_b32 s43, s41, 7
    s_add_u32 s42, s42, s43
    s_lshr_b32 s43, s38, 1
    s_lshl_b32 s43, s43, 13
    s_and_b32 s44, s38, 1
    s_lshl_b32 s44, s44, 10
    s_add_u32 s43, s43, s44
    s_bfe_u32 s46, s40, 0x10001
    v_and_b32 v9, 15, v0
    v_lshl_add_u32 v9, v9, 1, s46
    v_lshl_add_u32 v9, v9, 3, s36
    v_lshlrev_b32 v9, 7, v9
    v_add_u32 v5, s43, v3
    v_add_u32 v6, 0x10000, v5
    v_add_u32 v7, 0x20000, v5
    s_lshl_b32 s44, s38, 11
    v_add_u32 v8, s44, v3
    s_lshl_b32 s47, s36, 1
    s_and_b32 s48, s37, 1
    s_add_u32 s48, s48, s47
    s_add_u32 s47, s47, s46
    s_lshl_b32 s47, s47, 7
    s_add_u32 s47, s47, 20512896
    s_lshr_b32 s49, s37, 1
    s_lshl_b32 s45, s48, 5
    s_add_u32 s45, s45, s49
    s_lshl_b32 s45, s45, 2
    s_add_u32 s45, s45, 20512896
    s_mul_i32 s48, s48, 448
    s_mul_i32 s49, s49, 7
    s_add_u32 s48, s48, s49
    s_lshl_b32 s48, s48, 10
    s_add_u32 s48, s48, 9703424
    s_cmp_ge_u32 s2, 224
    s_cbranch_scc1 L_l4_44
    s_barrier
L_l4_44:
    s_barrier
    ds_write_b128 v10, v[136:139] offset:0
    ds_write_b128 v10, v[140:143] offset:1024
    ds_write_b128 v10, v[144:147] offset:2048
    ds_write_b128 v10, v[148:151] offset:3072
    ds_write_b128 v10, v[152:155] offset:4096
    ds_write_b128 v10, v[156:159] offset:5120
    ds_write_b128 v10, v[160:163] offset:6144
    ds_write_b128 v10, v[164:167] offset:28672
    ds_write_b128 v10, v[168:171] offset:29696
    ds_write_b128 v10, v[172:175] offset:30720
    ds_write_b128 v10, v[176:179] offset:31744
    ds_write_b128 v10, v[180:183] offset:32768
    ds_write_b128 v10, v[184:187] offset:33792
    ds_write_b128 v10, v[188:191] offset:34816
    ds_write_b128 v8, v[248:251] offset:57344
    ds_write_b128 v8, v[252:255] offset:58368
    s_waitcnt lgkmcnt(0)
    s_barrier
    s_waitcnt lgkmcnt(0)
    s_barrier
    s_add_u32 s50, s42, 43008
    buffer_load_dwordx4 v[12:15], v4, s[28:31], s50 offen
    s_add_u32 s50, s42, 57344
    buffer_load_dwordx4 v[16:19], v4, s[28:31], s50 offen
    s_add_u32 s50, s42, 143360
    buffer_load_dwordx4 v[20:23], v4, s[28:31], s50 offen
    s_add_u32 s50, s42, 157696
    buffer_load_dwordx4 v[24:27], v4, s[28:31], s50 offen
    s_add_u32 s50, s42, 243712
    buffer_load_dwordx4 v[28:31], v4, s[28:31], s50 offen
    s_add_u32 s50, s42, 258048
    buffer_load_dwordx4 v[32:35], v4, s[28:31], s50 offen
    s_add_u32 s50, s42, 344064
    buffer_load_dwordx4 v[36:39], v4, s[28:31], s50 offen
    s_add_u32 s50, s42, 358400
    buffer_load_dwordx4 v[40:43], v4, s[28:31], s50 offen
    s_waitcnt lgkmcnt(0)
    s_barrier
    ds_write_b128 v11, v[192:195] offset:0
    ds_write_b128 v11, v[196:199] offset:1024
    ds_write_b128 v11, v[200:203] offset:2048
    ds_write_b128 v11, v[204:207] offset:3072
    ds_write_b128 v11, v[208:211] offset:4096
    ds_write_b128 v11, v[212:215] offset:5120
    ds_write_b128 v11, v[216:219] offset:6144
    s_add_u32 s50, s42, 444416
    buffer_load_dwordx4 v[44:47], v4, s[28:31], s50 offen
    s_add_u32 s50, s42, 458752
    buffer_load_dwordx4 v[48:51], v4, s[28:31], s50 offen
    s_add_u32 s50, s42, 544768
    buffer_load_dwordx4 v[52:55], v4, s[28:31], s50 offen
    s_add_u32 s50, s42, 559104
    buffer_load_dwordx4 v[56:59], v4, s[28:31], s50 offen
    s_add_u32 s50, s42, 645120
    buffer_load_dwordx4 v[60:63], v4, s[28:31], s50 offen
    s_add_u32 s50, s42, 659456
    buffer_load_dwordx4 v[64:67], v4, s[28:31], s50 offen
    s_add_u32 s50, s42, 745472
    buffer_load_dwordx4 v[68:71], v4, s[28:31], s50 offen
    s_add_u32 s50, s42, 759808
    buffer_load_dwordx4 v[72:75], v4, s[28:31], s50 offen
    s_waitcnt lgkmcnt(0)
    s_barrier
    s_cmp_lg_u32 s3, 4
    s_cbranch_scc1 L_g_47
    buffer_load_dword v140, off, s[24:27], s47 sc1
L_g_47:
    ds_write_b128 v11, v[220:223] offset:28672
    ds_write_b128 v11, v[224:227] offset:29696
    ds_write_b128 v11, v[228:231] offset:30720
    ds_write_b128 v11, v[232:235] offset:31744
    ds_write_b128 v11, v[236:239] offset:32768
    ds_write_b128 v11, v[240:243] offset:33792
    ds_write_b128 v11, v[244:247] offset:34816
    s_add_u32 s50, s42, 71680
    buffer_load_dwordx4 v[76:79], v4, s[28:31], s50 offen
    s_add_u32 s50, s42, 86016
    buffer_load_dwordx4 v[80:83], v4, s[28:31], s50 offen
    s_add_u32 s50, s42, 172032
    buffer_load_dwordx4 v[84:87], v4, s[28:31], s50 offen
    s_add_u32 s50, s42, 186368
    buffer_load_dwordx4 v[88:91], v4, s[28:31], s50 offen
    s_add_u32 s50, s42, 272384
    buffer_load_dwordx4 v[92:95], v4, s[28:31], s50 offen
    s_add_u32 s50, s42, 286720
    buffer_load_dwordx4 v[96:99], v4, s[28:31], s50 offen
    s_add_u32 s50, s42, 372736
    buffer_load_dwordx4 v[100:103], v4, s[28:31], s50 offen
    s_add_u32 s50, s42, 387072
    buffer_load_dwordx4 v[104:107], v4, s[28:31], s50 offen
    s_waitcnt lgkmcnt(0)
    s_barrier
    s_add_u32 m0, s43, 135168
    s_add_u32 s50, s42, 0
    buffer_load_dwordx4 v4, s[28:31], s50 offen lds
    s_add_u32 m0, s43, 137216
    s_add_u32 s50, s42, 14336
    buffer_load_dwordx4 v4, s[28:31], s50 offen lds
    s_add_u32 m0, s43, 139264
    s_add_u32 s50, s42, 28672
    buffer_load_dwordx4 v4, s[28:31], s50 offen lds
    s_add_u32 m0, s43, 141312
    s_add_u32 s50, s42, 100352
    buffer_load_dwordx4 v4, s[28:31], s50 offen lds
    s_add_u32 s50, s42, 516096
    buffer_load_dwordx4 v[144:147], v4, s[28:31], s50 offen
    s_add_u32 s50, s42, 530432
    buffer_load_dwordx4 v[148:151], v4, s[28:31], s50 offen
    s_add_u32 s50, s42, 602112
    buffer_load_dwordx4 v[152:155], v4, s[28:31], s50 offen
    s_add_u32 s50, s42, 616448
    buffer_load_dwordx4 v[156:159], v4, s[28:31], s50 offen
    s_waitcnt lgkmcnt(0)
    s_barrier
    s_add_u32 s50, s42, 630784
    buffer_load_dwordx4 v[160:163], v4, s[28:31], s50 offen
    s_add_u32 s50, s42, 702464
    buffer_load_dwordx4 v[164:167], v4, s[28:31], s50 offen
    s_add_u32 s50, s42, 716800
    buffer_load_dwordx4 v[168:171], v4, s[28:31], s50 offen
    s_add_u32 s50, s42, 731136
    buffer_load_dwordx4 v[172:175], v4, s[28:31], s50 offen
    s_add_u32 s50, s42, 473088
    buffer_load_dwordx4 v[108:111], v4, s[28:31], s50 offen
    s_add_u32 s50, s42, 487424
    buffer_load_dwordx4 v[112:115], v4, s[28:31], s50 offen
    s_add_u32 s50, s42, 573440
    buffer_load_dwordx4 v[116:119], v4, s[28:31], s50 offen
    s_add_u32 s50, s42, 587776
    buffer_load_dwordx4 v[120:123], v4, s[28:31], s50 offen
    s_barrier
    s_cmp_lg_u32 s3, 5
    s_cbranch_scc1 L_g_48
    s_add_u32 s98, s97, 4
    v_mov_b32 v142, s98
    s_mov_b64 exec, 1
    buffer_store_dword v142, off, s[24:27], s45
    s_mov_b64 exec, -1
    s_lshl_b32 s58, s2, 7
    s_add_u32 s58, s58, 20447232
    v_mov_b32 v143, 4
    s_mov_b64 exec, 1
    buffer_store_dword v143, off, s[24:27], s58 sc1
    s_mov_b64 exec, -1
L_g_48:
    s_add_u32 m0, s43, 0
    s_add_u32 s50, s42, 114688
    buffer_load_dwordx4 v4, s[28:31], s50 offen lds
    s_add_u32 m0, s43, 2048
    s_add_u32 s50, s42, 129024
    buffer_load_dwordx4 v4, s[28:31], s50 offen lds
    s_add_u32 m0, s43, 4096
    s_add_u32 s50, s42, 200704
    buffer_load_dwordx4 v4, s[28:31], s50 offen lds
    s_add_u32 m0, s43, 6144
    s_add_u32 s50, s42, 215040
    buffer_load_dwordx4 v4, s[28:31], s50 offen lds
    s_add_u32 s50, s42, 673792
    buffer_load_dwordx4 v[124:127], v4, s[28:31], s50 offen
    s_add_u32 s50, s42, 688128
    buffer_load_dwordx4 v[128:131], v4, s[28:31], s50 offen
    s_add_u32 s50, s42, 774144
    buffer_load_dwordx4 v[132:135], v4, s[28:31], s50 offen
    s_add_u32 s50, s42, 788480
    buffer_load_dwordx4 v[136:139], v4, s[28:31], s50 offen
    s_waitcnt lgkmcnt(0)
    s_barrier
    s_cmp_lg_u32 s3, 4
    s_cbranch_scc1 L_g_49
    s_mov_b32 s58, 0x40000
    s_mov_b32 s57, 20447232
    s_add_u32 s98, s97, 4
    v_and_b32 v213, 15, v0
    v_lshlrev_b32 v213, 2, v213
L_lp_50:
    s_mov_b32 s59, 6
    buffer_load_dword v208, v213, s[24:27], s47 offen sc1
L_lf_51:
    s_waitcnt vmcnt(0)
    v_subrev_u32 v214, s98, v208
    v_cmp_le_u32 vcc, 4, v214
    s_nop 0
    s_cbranch_vccz L_dn_52
    buffer_load_dword v208, v213, s[24:27], s47 offen sc1
    s_sub_u32 s59, s59, 1
    s_cmp_lg_u32 s59, 0
    s_cbranch_scc1 L_lf_51
    buffer_load_dword v214, v9, s[24:27], s57 offen sc1
    s_sub_u32 s58, s58, 1
    s_waitcnt vmcnt(0)
    v_cmp_gt_u32 vcc, 4, v214
    s_cmp_lg_u32 s58, 0
    s_cbranch_vccz L_dn_52
    s_cbranch_scc1 L_lp_50
L_dn_52:
L_g_49:
    s_add_u32 m0, s43, 16384
    s_add_u32 s50, s42, 229376
    buffer_load_dwordx4 v4, s[28:31], s50 offen lds
    s_add_u32 m0, s43, 18432
    s_add_u32 s50, s42, 301056
    buffer_load_dwordx4 v4, s[28:31], s50 offen lds
    s_add_u32 m0, s43, 20480
    s_add_u32 s50, s42, 315392
    buffer_load_dwordx4 v4, s[28:31], s50 offen lds
    s_add_u32 m0, s43, 22528
    s_add_u32 s50, s42, 329728
    buffer_load_dwordx4 v4, s[28:31], s50 offen lds
    s_add_u32 m0, s43, 32768
    s_add_u32 s50, s42, 401408
    buffer_load_dwordx4 v4, s[28:31], s50 offen lds
    s_add_u32 m0, s43, 34816
    s_add_u32 s50, s42, 415744
    buffer_load_dwordx4 v4, s[28:31], s50 offen lds
    s_add_u32 m0, s43, 36864
    s_add_u32 s50, s42, 430080
    buffer_load_dwordx4 v4, s[28:31], s50 offen lds
    s_add_u32 m0, s43, 38912
    s_add_u32 s50, s42, 501760
    buffer_load_dwordx4 v4, s[28:31], s50 offen lds
    s_waitcnt vmcnt(12)
    s_waitcnt lgkmcnt(0)
    s_barrier
    ds_write_b128 v6, v[144:147] offset:0
    ds_write_b128 v6, v[148:151] offset:2048
    ds_write_b128 v6, v[152:155] offset:4096
    ds_write_b128 v6, v[156:159] offset:6144
    ds_write_b128 v6, v[160:163] offset:16384
    ds_write_b128 v6, v[164:167] offset:18432
    ds_write_b128 v6, v[168:171] offset:20480
    ds_write_b128 v6, v[172:175] offset:22528
    s_waitcnt vmcnt(0)
    v_add_u32 v141, 151552, v3
    s_waitcnt lgkmcnt(0)
    s_barrier
    s_cmp_lg_u32 s3, 5
    s_cbranch_scc1 L_g_53
    s_add_u32 s98, s97, 5
    v_mov_b32 v142, s98
    s_mov_b64 exec, 1
    buffer_store_dword v142, off, s[24:27], s45
    s_mov_b64 exec, -1
    s_lshl_b32 s58, s2, 7
    s_add_u32 s58, s58, 20447232
    v_mov_b32 v143, 5
    s_mov_b64 exec, 1
    buffer_store_dword v143, off, s[24:27], s58 sc1
    s_mov_b64 exec, -1
L_g_53:
    s_cmp_lg_u32 s3, 5
    s_cbranch_scc1 L_g_54
    ds_read_b128 v[176:179], v141 offset:0
    ds_read_b128 v[180:183], v141 offset:1024
    ds_read_b128 v[184:187], v141 offset:2048
    ds_read_b128 v[188:191], v141 offset:3072
    ds_read_b128 v[192:195], v141 offset:4096
    ds_read_b128 v[196:199], v141 offset:5120
    ds_read_b128 v[200:203], v141 offset:6144
    ds_read_b128 v[204:207], v141 offset:7168
    s_add_u32 s49, s48, 0
    s_waitcnt lgkmcnt(7)
    buffer_store_dwordx4 v[176:179], v3, s[24:27], s49 offen offset:1024 sc1
    s_add_u32 s49, s48, 114688
    s_waitcnt lgkmcnt(6)
    buffer_store_dwordx4 v[180:183], v3, s[24:27], s49 offen offset:1024 sc1
    s_add_u32 s49, s48, 229376
    s_waitcnt lgkmcnt(5)
    buffer_store_dwordx4 v[184:187], v3, s[24:27], s49 offen offset:1024 sc1
    s_add_u32 s49, s48, 344064
    s_waitcnt lgkmcnt(4)
    buffer_store_dwordx4 v[188:191], v3, s[24:27], s49 offen offset:1024 sc1
    s_add_u32 s49, s48, 0
    s_waitcnt lgkmcnt(3)
    buffer_store_dwordx4 v[192:195], v3, s[24:27], s49 offen offset:2048 sc1
    s_add_u32 s49, s48, 114688
    s_waitcnt lgkmcnt(2)
    buffer_store_dwordx4 v[196:199], v3, s[24:27], s49 offen offset:2048 sc1
    s_add_u32 s49, s48, 229376
    s_waitcnt lgkmcnt(1)
    buffer_store_dwordx4 v[200:203], v3, s[24:27], s49 offen offset:2048 sc1
    s_add_u32 s49, s48, 344064
    s_waitcnt lgkmcnt(0)
    buffer_store_dwordx4 v[204:207], v3, s[24:27], s49 offen offset:2048 sc1
L_g_54:
    s_cmp_lt_u32 s2, 224
    s_cbranch_scc1 L_l5_55
    s_cmp_lg_u32 s3, 5
    s_cbranch_scc1 L_g_56
    s_waitcnt vmcnt(0)
    s_add_u32 s98, s97, 6
    v_mov_b32 v142, s98
    s_mov_b64 exec, 1
    buffer_store_dword v142, off, s[24:27], s45
    s_mov_b64 exec, -1
    s_lshl_b32 s58, s2, 7
    s_add_u32 s58, s58, 20447232
    v_mov_b32 v143, 6
    s_mov_b64 exec, 1
    buffer_store_dword v143, off, s[24:27], s58 sc1
    s_mov_b64 exec, -1
L_g_56:
    s_branch L_end
L_l5_55:
    s_cmp_lg_u32 s3, 4
    s_cbranch_scc1 L_o_57
    s_mov_b32 s58, 0x40000
    s_mov_b32 s57, 20447232
    s_add_u32 s98, s97, 5
    v_and_b32 v213, 15, v0
    v_lshlrev_b32 v213, 2, v213
L_lp_59:
    s_mov_b32 s59, 6
    buffer_load_dword v208, v213, s[24:27], s47 offen sc1
L_lf_60:
    s_waitcnt vmcnt(0)
    v_subrev_u32 v214, s98, v208
    v_cmp_le_u32 vcc, 4, v214
    s_nop 0
    s_cbranch_vccz L_dn_61
    buffer_load_dword v208, v213, s[24:27], s47 offen sc1
    s_sub_u32 s59, s59, 1
    s_cmp_lg_u32 s59, 0
    s_cbranch_scc1 L_lf_60
    buffer_load_dword v214, v9, s[24:27], s57 offen sc1
    s_sub_u32 s58, s58, 1
    s_waitcnt vmcnt(0)
    v_cmp_gt_u32 vcc, 5, v214
    s_cmp_lg_u32 s58, 0
    s_cbranch_vccz L_dn_61
    s_cbranch_scc1 L_lp_59
L_dn_61:
    s_barrier
    ds_write_b128 v6, v[12:15] offset:32768
    ds_write_b128 v6, v[16:19] offset:34816
    ds_write_b128 v6, v[20:23] offset:36864
    ds_write_b128 v6, v[24:27] offset:38912
    ds_write_b128 v6, v[28:31] offset:49152
    ds_write_b128 v6, v[32:35] offset:51200
    ds_write_b128 v6, v[36:39] offset:53248
    ds_write_b128 v6, v[40:43] offset:55296
    ds_write_b128 v5, v[44:47] offset:49152
    ds_write_b128 v5, v[48:51] offset:51200
    ds_write_b128 v5, v[52:55] offset:53248
    ds_write_b128 v5, v[56:59] offset:55296
    s_branch L_j_58
L_o_57:
    ds_write_b128 v6, v[12:15] offset:32768
    ds_write_b128 v6, v[16:19] offset:34816
    ds_write_b128 v6, v[20:23] offset:36864
    ds_write_b128 v6, v[24:27] offset:38912
    ds_write_b128 v6, v[28:31] offset:49152
    ds_write_b128 v6, v[32:35] offset:51200
    ds_write_b128 v6, v[36:39] offset:53248
    ds_write_b128 v6, v[40:43] offset:55296
    ds_write_b128 v5, v[44:47] offset:49152
    ds_write_b128 v5, v[48:51] offset:51200
    ds_write_b128 v5, v[52:55] offset:53248
    ds_write_b128 v5, v[56:59] offset:55296
    s_barrier
L_j_58:
    s_cmp_lg_u32 s3, 5
    s_cbranch_scc1 L_g_62
    s_waitcnt vmcnt(0)
    s_add_u32 s98, s97, 6
    v_mov_b32 v142, s98
    s_mov_b64 exec, 1
    buffer_store_dword v142, off, s[24:27], s45
    s_mov_b64 exec, -1
    s_lshl_b32 s58, s2, 7
    s_add_u32 s58, s58, 20447232
    v_mov_b32 v143, 6
    s_mov_b64 exec, 1
    buffer_store_dword v143, off, s[24:27], s58 sc1
    s_mov_b64 exec, -1
L_g_62:
    s_waitcnt lgkmcnt(0)
    s_barrier
    s_cmp_lg_u32 s3, 4
    s_cbranch_scc1 L_o_63
    s_mov_b32 s58, 0x40000
    s_mov_b32 s57, 20447232
    s_add_u32 s98, s97, 6
    v_and_b32 v213, 15, v0
    v_lshlrev_b32 v213, 2, v213
L_lp_65:
    s_mov_b32 s59, 6
    buffer_load_dword v208, v213, s[24:27], s47 offen sc1
L_lf_66:
    s_waitcnt vmcnt(0)
    v_subrev_u32 v214, s98, v208
    v_cmp_le_u32 vcc, 4, v214
    s_nop 0
    s_cbranch_vccz L_dn_67
    buffer_load_dword v208, v213, s[24:27], s47 offen sc1
    s_sub_u32 s59, s59, 1
    s_cmp_lg_u32 s59, 0
    s_cbranch_scc1 L_lf_66
    buffer_load_dword v214, v9, s[24:27], s57 offen sc1
    s_sub_u32 s58, s58, 1
    s_waitcnt vmcnt(0)
    v_cmp_gt_u32 vcc, 6, v214
    s_cmp_lg_u32 s58, 0
    s_cbranch_vccz L_dn_67
    s_cbranch_scc1 L_lp_65
L_dn_67:
    s_barrier
    ds_write_b128 v7, v[60:63] offset:4096
    ds_write_b128 v7, v[64:67] offset:6144
    ds_write_b128 v7, v[68:71] offset:8192
    ds_write_b128 v7, v[72:75] offset:10240
    ds_write_b128 v5, v[76:79] offset:0
    ds_write_b128 v5, v[80:83] offset:2048
    ds_write_b128 v5, v[84:87] offset:4096
    ds_write_b128 v5, v[88:91] offset:6144
    ds_write_b128 v5, v[92:95] offset:16384
    ds_write_b128 v5, v[96:99] offset:18432
    ds_write_b128 v5, v[100:103] offset:20480
    ds_write_b128 v5, v[104:107] offset:22528
    s_branch L_j_64
L_o_63:
    ds_write_b128 v7, v[60:63] offset:4096
    ds_write_b128 v7, v[64:67] offset:6144
    ds_write_b128 v7, v[68:71] offset:8192
    ds_write_b128 v7, v[72:75] offset:10240
    ds_write_b128 v5, v[76:79] offset:0
    ds_write_b128 v5, v[80:83] offset:2048
    ds_write_b128 v5, v[84:87] offset:4096
    ds_write_b128 v5, v[88:91] offset:6144
    ds_write_b128 v5, v[92:95] offset:16384
    ds_write_b128 v5, v[96:99] offset:18432
    ds_write_b128 v5, v[100:103] offset:20480
    ds_write_b128 v5, v[104:107] offset:22528
    s_barrier
L_j_64:
    s_waitcnt vmcnt(0) lgkmcnt(0)
    s_barrier
    ds_write_b128 v5, v[108:111] offset:32768
    ds_write_b128 v5, v[112:115] offset:34816
    ds_write_b128 v5, v[116:119] offset:36864
    ds_write_b128 v5, v[120:123] offset:38912
    ds_write_b128 v6, v[124:127] offset:0
    ds_write_b128 v6, v[128:131] offset:2048
    ds_write_b128 v6, v[132:135] offset:4096
    ds_write_b128 v6, v[136:139] offset:6144
    s_waitcnt lgkmcnt(0)
    s_barrier
    s_barrier
L_end:
    s_endpgm
.section .rodata,"a"
.p2align 6
.amdhsa_kernel sequential_preLN__mha_block__glu_gated_reglu__prompt_kernel
  .amdhsa_next_free_vgpr 256
  .amdhsa_next_free_sgpr 100
  .amdhsa_accum_offset 256
  .amdhsa_group_segment_fixed_size 0
  .amdhsa_kernarg_size 80
  .amdhsa_user_sgpr_count 2
  .amdhsa_user_sgpr_kernarg_segment_ptr 1
  .amdhsa_system_sgpr_workgroup_id_x 1
  .amdhsa_float_denorm_mode_32 3
.end_amdhsa_kernel
```
